```python
import torch

def _softmax(x, axis=-1):
    return torch.softmax(x, dim=axis)
def _gelu(x):
    return torch.nn.functional.gelu(x, approximate="tanh")
def _silu(x):
    return torch.nn.functional.silu(x)
def _sigmoid(x):
    return torch.sigmoid(x)
def _layernorm(x, axis=-1, eps=1e-5):
    m = x.mean(dim=axis, keepdim=True)
    v = x.var(dim=axis, keepdim=True, unbiased=False)
    return (x - m) / torch.sqrt(v + eps)
def _scatter_add(tgt, idx, src, axis=0):
    return tgt.clone().index_add_(axis, idx, src)
def _segment_sum(src, seg, n):
    out = torch.zeros((n,) + src.shape[1:], dtype=src.dtype)
    return out.index_add_(0, seg, src)
def _pad(x, pw):
    flat = tuple(v for pair in reversed(pw) for v in pair)
    return torch.nn.functional.pad(x, flat)

kernel_name = 'gated_mix__mha_block__ssm_conv_s5__prompt'

def setup_inputs():

    _w = (lambda a: (lambda t: t.to(torch.bfloat16) if t.is_floating_point() else t)(torch.as_tensor(a)))
    def _A_setup():
        B, S, D, H = 1, 2048, 512, 32
        return {
            "x": _w((lambda *s: torch.randn(*s, dtype=torch.bfloat16) * 0.05)(B, S, D)),
            "wqkv": _w((lambda *s: torch.randn(*s, dtype=torch.bfloat16) * 0.8)(D, 3 * D)),
            "wo": _w((lambda *s: torch.randn(*s, dtype=torch.bfloat16) * 0.05)(D, D)),
        }
    _A_in = _A_setup()

    def _B_setup():
        B, S, D = 1, 2048, 512
        P = D
        Lambda_re = -0.5 * (lambda _x: torch.exp(torch.as_tensor(_x)))((lambda *s: torch.randn(*s, dtype=torch.bfloat16) * 0.4)(P))
        Lambda_im = (lambda *s: torch.randn(*s, dtype=torch.bfloat16) * 0.8)(P) * 1.0
        B_re = (lambda *s: torch.randn(*s, dtype=torch.bfloat16) * 0.8)(P, D) * (D ** -0.5)
        B_im = (lambda *s: torch.randn(*s, dtype=torch.bfloat16) * 0.8)(P, D) * (D ** -0.5)
        C_re = (lambda *s: torch.randn(*s, dtype=torch.bfloat16) * 0.8)(D, P) * (P ** -0.5)
        C_im = (lambda *s: torch.randn(*s, dtype=torch.bfloat16) * 0.8)(D, P) * (P ** -0.5)
        log_dt = (lambda *s: torch.randn(*s, dtype=torch.bfloat16) * 0.4)(P) * 0.3 - 2.0
        Dskip = (lambda *s: torch.randn(*s, dtype=torch.bfloat16) * 0.1)(D)
        return {
            "x": _w((lambda *s: torch.randn(*s, dtype=torch.bfloat16) * 0.05)(B, S, D)),
            "Lambda_re": _w(Lambda_re),
            "Lambda_im": _w(Lambda_im),
            "B_re": _w(B_re),
            "B_im": _w(B_im),
            "C_re": _w(C_re),
            "C_im": _w(C_im),
            "log_dt": _w(log_dt),
            "Dskip": _w(Dskip),
        }
    _B_in = _B_setup()

    return {
        "A_x": _A_in["x"],
        "A_wqkv": _A_in["wqkv"],
        "A_wo": _A_in["wo"],
        "B_x": _B_in["x"],
        "B_Lambda_re": _B_in["Lambda_re"],
        "B_Lambda_im": _B_in["Lambda_im"],
        "B_B_re": _B_in["B_re"],
        "B_B_im": _B_in["B_im"],
        "B_C_re": _B_in["C_re"],
        "B_C_im": _B_in["C_im"],
        "B_log_dt": _B_in["log_dt"],
        "B_Dskip": _B_in["Dskip"],
        "gate_w": _w((lambda *s: torch.randn(*s, dtype=torch.bfloat16) * 0.05)(512) * 16.0),
    }

def reference(A_x, A_wqkv, A_wo, B_x, B_Lambda_re, B_Lambda_im, B_B_re, B_B_im, B_C_re, B_C_im, B_log_dt, B_Dskip, gate_w):
    def _A_ref(x, wqkv, wo):
        B, S, D = x.shape
        H = 32
        Dh = D // H
        qkv = (lambda x, *d: x.permute(*d))((x @ wqkv).reshape(B, S, 3, H, Dh), 2, 0, 3, 1, 4)
        q, k, v = qkv[0], qkv[1], qkv[2]
        scores = torch.einsum("bhqd,bhkd->bhqk", q, k) * (Dh ** -0.5)
        p = _softmax(scores, axis=-1)
        o = torch.einsum("bhqk,bhkd->bhqd", p, v)
        return (lambda x, *d: x.permute(*d))(o, 0, 2, 1, 3).reshape(B, S, D) @ wo

    def _B_ref(x, Lambda_re, Lambda_im, B_re, B_im, C_re, C_im, log_dt, Dskip):
        Bsz, L, H = x.shape
        Lam = Lambda_re + 1j * Lambda_im
        Bmat = B_re + 1j * B_im
        Cmat = C_re + 1j * C_im
        dt = torch.exp(log_dt)
        Lam_bar = torch.exp(dt * Lam)
        B_bar = ((Lam_bar - 1.0) / Lam)[:, None] * Bmat
        Bu = torch.einsum("bld,pd->blp", x + 0j, B_bar)
        h = torch.zeros_like(Bu[:, 0, :])
        hs = []
        for t in range(L):
            h = Lam_bar[None, :] * h + Bu[:, t, :]
            hs.append(h)
        hseq = torch.stack(hs, 1)
        y = 2.0 * torch.einsum("blp,dp->bld", hseq, Cmat).real + x * Dskip[None, None, :]
        return y

    x = A_x
    g = _sigmoid((x * gate_w).sum(-1, keepdims=True))
    a = _A_ref(x, A_wqkv, A_wo)
    b = _B_ref(x, B_Lambda_re, B_Lambda_im, B_B_re, B_B_im, B_C_re, B_C_im, B_log_dt, B_Dskip)
    return g * a + (1 - g) * b
```

```asm
; @launch grid=(256,1,1) block=(512,1,1) lds=139520
.amdgcn_target "amdgcn-amd-amdhsa--gfx950"
.text
.globl gated_mix__mha_block__ssm_conv_s5__prompt_kernel
.p2align 8
.type gated_mix__mha_block__ssm_conv_s5__prompt_kernel,@function
gated_mix__mha_block__ssm_conv_s5__prompt_kernel:
  s_cmp_ge_u32 s2, 256
  s_cbranch_scc1 L_f_exit
  s_load_dwordx2 s[4:5], s[0:1], 120
  s_load_dwordx2 s[8:9], s[0:1], 0
  s_load_dwordx2 s[12:13], s[0:1], 8
  s_load_dwordx2 s[16:17], s[0:1], 48
  s_load_dwordx2 s[20:21], s[0:1], 56
  v_lshrrev_b32 v2, 6, v0
  v_and_b32 v0, 63, v0
  v_readfirstlane_b32 s30, v2
  s_and_b32 s29, s2, 1
  s_lshl_b32 s29, s29, 3
  s_bfe_u32 s36, s2, 0x30003
  s_add_u32 s29, s29, s36
  s_bfe_u32 s28, s2, 0x20001
  s_lshl_b32 s28, s28, 2
  s_lshr_b32 s36, s2, 6
  s_add_u32 s28, s28, s36
  v_lshlrev_b32 v1, 4, v0
  s_and_b32 s31, s30, 3
  s_cmp_ge_u32 s30, 4
  s_cbranch_scc1 L_f_helper
  s_waitcnt lgkmcnt(0)
  s_mov_b32 s6, 0x1650000
  s_mov_b32 s7, 0x00020000
  s_mov_b32 s10, 0x200000
  s_mov_b32 s11, 0x00020000
  s_mov_b32 s14, 0x180000
  s_mov_b32 s15, 0x00020000
  s_mov_b32 s18, 0x80000
  s_mov_b32 s19, 0x00020000
  s_mov_b32 s22, 0x80000
  s_mov_b32 s23, 0x00020000
  s_barrier
  v_and_b32 v119, 31, v0
  v_lshlrev_b32 v119, 7, v119
  s_lshl_b32 s54, s28, 3
  s_and_b32 s36, s29, 7
  s_add_u32 s54, s54, s36
  s_lshl_b32 s54, s54, 12
  s_cmp_eq_u32 s31, 1
  s_cbranch_scc1 L_touch1
  s_cmp_eq_u32 s31, 2
  s_cbranch_scc1 L_touch2
  s_cmp_eq_u32 s31, 3
  s_cbranch_scc1 L_touch3
  v_and_b32 v100, 31, v0
  v_lshlrev_b32 v100, 10, v100
  v_lshrrev_b32 v101, 5, v0
  v_lshl_add_u32 v100, v101, 7, v100
  s_and_b32 s36, s28, 3
  s_lshl_b32 s36, s36, 15
  s_lshl_b32 s37, s29, 17
  s_add_u32 s36, s36, s37
  buffer_load_dword v117, v100, s[8:11], s36 offen offset:256
  buffer_load_dword v117, v100, s[8:11], s36 offen offset:512
  buffer_load_dword v117, v100, s[8:11], s36 offen offset:768
  s_branch L_touchd
L_touch1:
  v_and_b32 v100, 15, v0
  v_mul_u32_u24 v100, 3072, v100
  v_lshrrev_b32 v101, 4, v0
  v_min_u32 v101, 2, v101
  v_lshl_add_u32 v100, v101, 10, v100
  s_and_b32 s36, s29, 7
  s_lshl_b32 s36, s36, 1
  s_and_b32 s37, s28, 1
  s_add_u32 s36, s36, s37
  s_mul_i32 s36, s36, 24
  s_add_u32 s36, s36, 128
  s_mul_i32 s36, s36, 3072
  s_lshr_b32 s37, s28, 1
  s_lshl_b32 s37, s37, 7
  s_add_u32 s36, s36, s37
  buffer_load_dword v117, v100, s[12:15], s36 offen
  s_add_u32 s36, s36, 49152
  buffer_load_dword v117, v100, s[12:15], s36 offen
  s_branch L_touchd
L_touch2:
  v_and_b32 v100, 31, v0
  v_lshlrev_b32 v100, 7, v100
  s_lshl_b32 s36, s28, 3
  s_and_b32 s37, s29, 7
  s_add_u32 s36, s36, s37
  s_lshl_b32 s36, s36, 12
  s_branch L_touchd
L_touch3:
L_touchd:
  v_mov_b32 v116, 0
  s_mov_b32 s36, 23265280
  buffer_load_dword v116, v116, s[4:7], s36 offen sc1
  v_and_b32 v100, 31, v0
  v_lshrrev_b32 v101, 5, v0
  v_bfe_u32 v102, v0, 1, 3
  v_lshlrev_b32 v103, 7, v100
  s_lshl_b32 s36, s31, 12
  v_add_u32 v104, 0, v101
  v_xor_b32 v104, v104, v102
  v_lshl_add_u32 v104, v104, 4, v103
  v_add_u32 v8, s36, v104
  v_add_u32 v13, 65536, v104
  v_add_u32 v104, 2, v101
  v_xor_b32 v104, v104, v102
  v_lshl_add_u32 v104, v104, 4, v103
  v_add_u32 v9, s36, v104
  v_add_u32 v14, 65536, v104
  v_add_u32 v104, 4, v101
  v_xor_b32 v104, v104, v102
  v_lshl_add_u32 v104, v104, 4, v103
  v_add_u32 v10, s36, v104
  v_add_u32 v15, 65536, v104
  v_add_u32 v104, 6, v101
  v_xor_b32 v104, v104, v102
  v_lshl_add_u32 v104, v104, 4, v103
  v_add_u32 v11, s36, v104
  v_add_u32 v16, 65536, v104
  v_bfe_u32 v100, v0, 2, 2
  v_lshl_add_u32 v100, v101, 3, v100
  v_mul_u32_u24 v100, 192, v100
  v_bfe_u32 v102, v0, 4, 1
  v_lshlrev_b32 v102, 5, v102
  v_and_b32 v103, 3, v0
  v_lshlrev_b32 v103, 3, v103
  v_add3_u32 v12, v100, v102, v103
  v_add_u32 v12, 65536, v12
  s_lshl_b32 s97, s29, 2
  s_add_u32 s97, s97, s31
  s_lshl_b32 s98, s28, 7
  s_add_u32 s97, s97, s98
  s_lshl_b32 s97, s97, 11
  s_add_u32 s97, s97, 2097152
  s_add_u32 s98, s97, 131072
  v_lshrrev_b32 v100, 5, v0
  v_and_b32 v101, 15, v0
  v_lshlrev_b32 v101, 4, v101
  v_lshl_add_u32 v100, v100, 8, v101
  v_bfe_u32 v101, v0, 4, 1
  v_lshl_add_u32 v108, v101, 17, v100
  v_lshl_add_u32 v110, v101, 13, v100
  s_lshl_b32 s36, s31, 11
  s_add_u32 s36, s36, 122880
  v_add_u32 v109, s36, v1
  s_add_u32 s36, s36, 1024
  v_add_u32 v110, s36, v110
  s_lshl_b32 s36, s31, 11
  s_add_u32 s36, s36, 114688
  v_add_u32 v111, s36, v1
  s_and_b32 s33, s30, 1
  s_bfe_u32 s36, s30, 0x10001
  s_lshl_b32 s32, s28, 1
  s_add_u32 s32, s32, s36
  s_mov_b32 s40, 0x0000ffff
  s_mov_b32 s41, 0x0000ffff
  s_lshl_b32 s34, s32, 6
  s_lshl_b32 s36, s33, 1
  s_add_u32 s34, s34, s36
  s_lshl_b32 s34, s34, 11
  s_add_u32 s34, s34, 2097152
  s_add_u32 s38, s29, 1
  s_and_b32 s38, s38, 15
  s_lshl_b32 s38, s38, 13
  v_and_b32 v2, 15, v0
  v_lshlrev_b32 v2, 4, v2
  v_lshrrev_b32 v100, 5, v0
  v_lshl_add_u32 v2, v100, 8, v2
  v_mov_b32 v112, v2
  v_add_u32 v3, s34, v1
  v_add_u32 v2, s34, v2
  v_and_b32 v102, 27, v0
  v_cmp_eq_u32 vcc, 16, v102
  v_mov_b32 v102, 0x3f803f80
  s_nop 0
  v_cndmask_b32 v102, 0, v102, vcc
  v_mov_b32 v156, v102
  v_mov_b32 v157, v102
  v_mov_b32 v158, v102
  v_mov_b32 v159, v102
  v_mov_b32 v160, v102
  v_mov_b32 v161, v102
  v_mov_b32 v162, v102
  v_mov_b32 v163, v102
  v_mov_b32 v164, v102
  v_mov_b32 v165, v102
  v_mov_b32 v166, v102
  v_mov_b32 v167, v102
  v_mov_b32 v168, v102
  v_mov_b32 v169, v102
  v_mov_b32 v170, v102
  v_mov_b32 v171, v102
  v_mov_b32 v172, v102
  v_mov_b32 v173, v102
  v_mov_b32 v174, v102
  v_mov_b32 v175, v102
  v_mov_b32 v176, v102
  v_mov_b32 v177, v102
  v_mov_b32 v178, v102
  v_mov_b32 v179, v102
  v_mov_b32 v180, v102
  v_mov_b32 v181, v102
  v_mov_b32 v182, v102
  v_mov_b32 v183, v102
  v_mov_b32 v184, v102
  v_mov_b32 v185, v102
  v_mov_b32 v186, v102
  v_mov_b32 v187, v102
  v_mov_b32 v188, v102
  v_mov_b32 v189, v102
  v_mov_b32 v190, v102
  v_mov_b32 v191, v102
  v_mov_b32 v192, v102
  v_mov_b32 v193, v102
  v_mov_b32 v194, v102
  v_mov_b32 v195, v102
  v_mov_b32 v196, v102
  v_mov_b32 v197, v102
  v_mov_b32 v198, v102
  v_mov_b32 v199, v102
  v_mov_b32 v200, v102
  v_mov_b32 v201, v102
  v_mov_b32 v202, v102
  v_mov_b32 v203, v102
  v_mov_b32 v204, v102
  v_mov_b32 v205, v102
  v_mov_b32 v206, v102
  v_mov_b32 v207, v102
  v_mov_b32 v208, v102
  v_mov_b32 v209, v102
  v_mov_b32 v210, v102
  v_mov_b32 v211, v102
  v_mov_b32 v212, v102
  v_mov_b32 v213, v102
  v_mov_b32 v214, v102
  v_mov_b32 v215, v102
  v_mov_b32 v216, v102
  v_mov_b32 v217, v102
  v_mov_b32 v218, v102
  v_mov_b32 v219, v102
  s_mov_b32 s100, 0x3eb8aa3b
  s_mov_b32 s101, 0x3eb8aa3b
  s_mov_b32 s55, 0
  v_mov_b32 v20, 0
  v_mov_b32 v21, 0
  v_mov_b32 v22, 0
  v_mov_b32 v23, 0
  v_mov_b32 v24, 0
  v_mov_b32 v25, 0
  v_mov_b32 v26, 0
  v_mov_b32 v27, 0
  v_mov_b32 v28, 0
  v_mov_b32 v29, 0
  v_mov_b32 v30, 0
  v_mov_b32 v31, 0
  v_mov_b32 v32, 0
  v_mov_b32 v33, 0
  v_mov_b32 v34, 0
  v_mov_b32 v35, 0
  v_mov_b32 v36, 0
  v_mov_b32 v37, 0
  v_mov_b32 v38, 0
  v_mov_b32 v39, 0
  v_mov_b32 v40, 0
  v_mov_b32 v41, 0
  v_mov_b32 v42, 0
  v_mov_b32 v43, 0
  v_mov_b32 v44, 0
  v_mov_b32 v45, 0
  v_mov_b32 v46, 0
  v_mov_b32 v47, 0
  v_mov_b32 v48, 0
  v_mov_b32 v49, 0
  v_mov_b32 v50, 0
  v_mov_b32 v51, 0
  v_mov_b32 v124, 0
  v_mov_b32 v125, 0
  v_mov_b32 v126, 0
  v_mov_b32 v127, 0
  v_mov_b32 v128, 0
  v_mov_b32 v129, 0
  v_mov_b32 v130, 0
  v_mov_b32 v131, 0
  v_mov_b32 v132, 0
  v_mov_b32 v133, 0
  v_mov_b32 v134, 0
  v_mov_b32 v135, 0
  v_mov_b32 v136, 0
  v_mov_b32 v137, 0
  v_mov_b32 v138, 0
  v_mov_b32 v139, 0
  v_mov_b32 v140, 0
  v_mov_b32 v141, 0
  v_mov_b32 v142, 0
  v_mov_b32 v143, 0
  v_mov_b32 v144, 0
  v_mov_b32 v145, 0
  v_mov_b32 v146, 0
  v_mov_b32 v147, 0
  v_mov_b32 v148, 0
  v_mov_b32 v149, 0
  v_mov_b32 v150, 0
  v_mov_b32 v151, 0
  v_mov_b32 v152, 0
  v_mov_b32 v153, 0
  v_mov_b32 v154, 0
  v_mov_b32 v155, 0
  v_mov_b32 v220, 0
  v_mov_b32 v221, 0
  v_mov_b32 v222, 0
  v_mov_b32 v223, 0
  v_mov_b32 v224, 0
  v_mov_b32 v225, 0
  v_mov_b32 v226, 0
  v_mov_b32 v227, 0
  v_mov_b32 v228, 0
  v_mov_b32 v229, 0
  v_mov_b32 v230, 0
  v_mov_b32 v231, 0
  v_mov_b32 v232, 0
  v_mov_b32 v233, 0
  v_mov_b32 v234, 0
  v_mov_b32 v235, 0
  s_barrier
  ds_read_b128 v[52:55], v8 offset:0
  ds_read_b64_tr_b16 v[56:57], v12 offset:0
  ds_read_b64_tr_b16 v[58:59], v12 offset:768
  ds_read_b64_tr_b16 v[60:61], v12 offset:64
  ds_read_b64_tr_b16 v[62:63], v12 offset:832
  ds_read_b64_tr_b16 v[64:65], v12 offset:128
  ds_read_b64_tr_b16 v[66:67], v12 offset:896
  ds_read_b128 v[68:71], v9 offset:0
  ds_read_b64_tr_b16 v[72:73], v12 offset:3072
  ds_read_b64_tr_b16 v[74:75], v12 offset:3840
  ds_read_b64_tr_b16 v[76:77], v12 offset:3136
  ds_read_b64_tr_b16 v[78:79], v12 offset:3904
  ds_read_b64_tr_b16 v[80:81], v12 offset:3200
  ds_read_b64_tr_b16 v[82:83], v12 offset:3968
  ds_read_b128 v[84:87], v10 offset:0
  ds_read_b64_tr_b16 v[88:89], v12 offset:6144
  ds_read_b64_tr_b16 v[90:91], v12 offset:6912
  ds_read_b64_tr_b16 v[92:93], v12 offset:6208
  ds_read_b64_tr_b16 v[94:95], v12 offset:6976
  ds_read_b64_tr_b16 v[96:97], v12 offset:6272
  ds_read_b64_tr_b16 v[98:99], v12 offset:7040
  s_waitcnt lgkmcnt(14)
  v_mfma_f32_32x32x16_bf16 v[124:139], v[56:59], v[52:55], v[124:139]
  v_mfma_f32_32x32x16_bf16 v[140:155], v[60:63], v[52:55], v[140:155]
  v_mfma_f32_32x32x16_bf16 v[220:235], v[52:55], v[64:67], v[220:235]
  ds_read_b128 v[52:55], v11 offset:0
  ds_read_b64_tr_b16 v[56:57], v12 offset:9216
  ds_read_b64_tr_b16 v[58:59], v12 offset:9984
  ds_read_b64_tr_b16 v[60:61], v12 offset:9280
  ds_read_b64_tr_b16 v[62:63], v12 offset:10048
  ds_read_b64_tr_b16 v[64:65], v12 offset:9344
  ds_read_b64_tr_b16 v[66:67], v12 offset:10112
  s_waitcnt lgkmcnt(14)
  v_mfma_f32_32x32x16_bf16 v[124:139], v[72:75], v[68:71], v[124:139]
  v_mfma_f32_32x32x16_bf16 v[140:155], v[76:79], v[68:71], v[140:155]
  v_mfma_f32_32x32x16_bf16 v[220:235], v[68:71], v[80:83], v[220:235]
  s_barrier
  ds_read_b128 v[68:71], v8 offset:16384
  ds_read_b64_tr_b16 v[72:73], v12 offset:12288
  ds_read_b64_tr_b16 v[74:75], v12 offset:13056
  ds_read_b64_tr_b16 v[76:77], v12 offset:12352
  ds_read_b64_tr_b16 v[78:79], v12 offset:13120
  ds_read_b64_tr_b16 v[80:81], v12 offset:12416
  ds_read_b64_tr_b16 v[82:83], v12 offset:13184
  s_waitcnt lgkmcnt(14)
  v_mfma_f32_32x32x16_bf16 v[124:139], v[88:91], v[84:87], v[124:139]
  v_mfma_f32_32x32x16_bf16 v[140:155], v[92:95], v[84:87], v[140:155]
  v_mfma_f32_32x32x16_bf16 v[220:235], v[84:87], v[96:99], v[220:235]
  s_cmp_lg_u32 s31, 2
  s_cbranch_scc1 L_f_nobt
  buffer_load_dword v117, v119, s[16:19], s54 offen
  buffer_load_dword v118, v119, s[20:23], s54 offen
L_f_nobt:
  ds_read_b128 v[84:87], v9 offset:16384
  ds_read_b64_tr_b16 v[88:89], v12 offset:15360
  ds_read_b64_tr_b16 v[90:91], v12 offset:16128
  ds_read_b64_tr_b16 v[92:93], v12 offset:15424
  ds_read_b64_tr_b16 v[94:95], v12 offset:16192
  ds_read_b64_tr_b16 v[96:97], v12 offset:15488
  ds_read_b64_tr_b16 v[98:99], v12 offset:16256
  s_waitcnt lgkmcnt(14)
  v_mfma_f32_32x32x16_bf16 v[124:139], v[56:59], v[52:55], v[124:139]
  v_mfma_f32_32x32x16_bf16 v[140:155], v[60:63], v[52:55], v[140:155]
  v_mfma_f32_32x32x16_bf16 v[220:235], v[52:55], v[64:67], v[220:235]
  ds_read_b128 v[52:55], v10 offset:16384
  ds_read_b64_tr_b16 v[56:57], v12 offset:18432
  ds_read_b64_tr_b16 v[58:59], v12 offset:19200
  ds_read_b64_tr_b16 v[60:61], v12 offset:18496
  ds_read_b64_tr_b16 v[62:63], v12 offset:19264
  ds_read_b64_tr_b16 v[64:65], v12 offset:18560
  ds_read_b64_tr_b16 v[66:67], v12 offset:19328
  s_waitcnt lgkmcnt(14)
  v_mfma_f32_32x32x16_bf16 v[124:139], v[72:75], v[68:71], v[124:139]
  v_mfma_f32_32x32x16_bf16 v[140:155], v[76:79], v[68:71], v[140:155]
  v_mfma_f32_32x32x16_bf16 v[220:235], v[68:71], v[80:83], v[220:235]
  ds_read_b128 v[68:71], v11 offset:16384
  ds_read_b64_tr_b16 v[72:73], v12 offset:21504
  ds_read_b64_tr_b16 v[74:75], v12 offset:22272
  ds_read_b64_tr_b16 v[76:77], v12 offset:21568
  ds_read_b64_tr_b16 v[78:79], v12 offset:22336
  ds_read_b64_tr_b16 v[80:81], v12 offset:21632
  ds_read_b64_tr_b16 v[82:83], v12 offset:22400
  s_waitcnt lgkmcnt(14)
  v_mfma_f32_32x32x16_bf16 v[124:139], v[88:91], v[84:87], v[124:139]
  v_mfma_f32_32x32x16_bf16 v[140:155], v[92:95], v[84:87], v[140:155]
  v_mfma_f32_32x32x16_bf16 v[220:235], v[84:87], v[96:99], v[220:235]
  s_barrier
  ds_read_b128 v[84:87], v8 offset:32768
  ds_read_b64_tr_b16 v[88:89], v12 offset:24576
  ds_read_b64_tr_b16 v[90:91], v12 offset:25344
  ds_read_b64_tr_b16 v[92:93], v12 offset:24640
  ds_read_b64_tr_b16 v[94:95], v12 offset:25408
  ds_read_b64_tr_b16 v[96:97], v12 offset:24704
  ds_read_b64_tr_b16 v[98:99], v12 offset:25472
  s_waitcnt lgkmcnt(14)
  v_mfma_f32_32x32x16_bf16 v[124:139], v[56:59], v[52:55], v[124:139]
  v_mfma_f32_32x32x16_bf16 v[140:155], v[60:63], v[52:55], v[140:155]
  v_mfma_f32_32x32x16_bf16 v[220:235], v[52:55], v[64:67], v[220:235]
  ds_read_b128 v[52:55], v9 offset:32768
  ds_read_b64_tr_b16 v[56:57], v12 offset:27648
  ds_read_b64_tr_b16 v[58:59], v12 offset:28416
  ds_read_b64_tr_b16 v[60:61], v12 offset:27712
  ds_read_b64_tr_b16 v[62:63], v12 offset:28480
  ds_read_b64_tr_b16 v[64:65], v12 offset:27776
  ds_read_b64_tr_b16 v[66:67], v12 offset:28544
  s_waitcnt lgkmcnt(14)
  v_mfma_f32_32x32x16_bf16 v[124:139], v[72:75], v[68:71], v[124:139]
  v_mfma_f32_32x32x16_bf16 v[140:155], v[76:79], v[68:71], v[140:155]
  v_mfma_f32_32x32x16_bf16 v[220:235], v[68:71], v[80:83], v[220:235]
  ds_read_b128 v[68:71], v10 offset:32768
  ds_read_b64_tr_b16 v[72:73], v12 offset:30720
  ds_read_b64_tr_b16 v[74:75], v12 offset:31488
  ds_read_b64_tr_b16 v[76:77], v12 offset:30784
  ds_read_b64_tr_b16 v[78:79], v12 offset:31552
  ds_read_b64_tr_b16 v[80:81], v12 offset:30848
  ds_read_b64_tr_b16 v[82:83], v12 offset:31616
  s_waitcnt lgkmcnt(14)
  v_mfma_f32_32x32x16_bf16 v[124:139], v[88:91], v[84:87], v[124:139]
  v_mfma_f32_32x32x16_bf16 v[140:155], v[92:95], v[84:87], v[140:155]
  v_mfma_f32_32x32x16_bf16 v[220:235], v[84:87], v[96:99], v[220:235]
  ds_read_b128 v[84:87], v11 offset:32768
  ds_read_b64_tr_b16 v[88:89], v12 offset:33792
  ds_read_b64_tr_b16 v[90:91], v12 offset:34560
  ds_read_b64_tr_b16 v[92:93], v12 offset:33856
  ds_read_b64_tr_b16 v[94:95], v12 offset:34624
  ds_read_b64_tr_b16 v[96:97], v12 offset:33920
  ds_read_b64_tr_b16 v[98:99], v12 offset:34688
  s_waitcnt lgkmcnt(14)
  v_mfma_f32_32x32x16_bf16 v[124:139], v[56:59], v[52:55], v[124:139]
  v_mfma_f32_32x32x16_bf16 v[140:155], v[60:63], v[52:55], v[140:155]
  v_mfma_f32_32x32x16_bf16 v[220:235], v[52:55], v[64:67], v[220:235]
  s_barrier
  ds_read_b128 v[52:55], v8 offset:49152
  ds_read_b64_tr_b16 v[56:57], v12 offset:36864
  ds_read_b64_tr_b16 v[58:59], v12 offset:37632
  ds_read_b64_tr_b16 v[60:61], v12 offset:36928
  ds_read_b64_tr_b16 v[62:63], v12 offset:37696
  ds_read_b64_tr_b16 v[64:65], v12 offset:36992
  ds_read_b64_tr_b16 v[66:67], v12 offset:37760
  s_waitcnt lgkmcnt(14)
  v_mfma_f32_32x32x16_bf16 v[124:139], v[72:75], v[68:71], v[124:139]
  v_mfma_f32_32x32x16_bf16 v[140:155], v[76:79], v[68:71], v[140:155]
  v_mfma_f32_32x32x16_bf16 v[220:235], v[68:71], v[80:83], v[220:235]
  ds_read_b128 v[68:71], v9 offset:49152
  ds_read_b64_tr_b16 v[72:73], v12 offset:39936
  ds_read_b64_tr_b16 v[74:75], v12 offset:40704
  ds_read_b64_tr_b16 v[76:77], v12 offset:40000
  ds_read_b64_tr_b16 v[78:79], v12 offset:40768
  ds_read_b64_tr_b16 v[80:81], v12 offset:40064
  ds_read_b64_tr_b16 v[82:83], v12 offset:40832
  s_waitcnt lgkmcnt(14)
  v_mfma_f32_32x32x16_bf16 v[124:139], v[88:91], v[84:87], v[124:139]
  v_mfma_f32_32x32x16_bf16 v[140:155], v[92:95], v[84:87], v[140:155]
  v_mfma_f32_32x32x16_bf16 v[220:235], v[84:87], v[96:99], v[220:235]
  ds_read_b128 v[84:87], v10 offset:49152
  ds_read_b64_tr_b16 v[88:89], v12 offset:43008
  ds_read_b64_tr_b16 v[90:91], v12 offset:43776
  ds_read_b64_tr_b16 v[92:93], v12 offset:43072
  ds_read_b64_tr_b16 v[94:95], v12 offset:43840
  ds_read_b64_tr_b16 v[96:97], v12 offset:43136
  ds_read_b64_tr_b16 v[98:99], v12 offset:43904
  s_waitcnt lgkmcnt(14)
  v_mfma_f32_32x32x16_bf16 v[124:139], v[56:59], v[52:55], v[124:139]
  v_mfma_f32_32x32x16_bf16 v[140:155], v[60:63], v[52:55], v[140:155]
  v_mfma_f32_32x32x16_bf16 v[220:235], v[52:55], v[64:67], v[220:235]
  ds_read_b128 v[52:55], v11 offset:49152
  ds_read_b64_tr_b16 v[56:57], v12 offset:46080
  ds_read_b64_tr_b16 v[58:59], v12 offset:46848
  ds_read_b64_tr_b16 v[60:61], v12 offset:46144
  ds_read_b64_tr_b16 v[62:63], v12 offset:46912
  ds_read_b64_tr_b16 v[64:65], v12 offset:46208
  ds_read_b64_tr_b16 v[66:67], v12 offset:46976
  s_waitcnt lgkmcnt(14)
  v_mfma_f32_32x32x16_bf16 v[124:139], v[72:75], v[68:71], v[124:139]
  v_mfma_f32_32x32x16_bf16 v[140:155], v[76:79], v[68:71], v[140:155]
  v_mfma_f32_32x32x16_bf16 v[220:235], v[68:71], v[80:83], v[220:235]
  s_barrier
  ds_read_b128 v[68:71], v8 offset:0
  ds_read_b64_tr_b16 v[72:73], v12 offset:0
  ds_read_b64_tr_b16 v[74:75], v12 offset:768
  ds_read_b64_tr_b16 v[76:77], v12 offset:64
  ds_read_b64_tr_b16 v[78:79], v12 offset:832
  ds_read_b64_tr_b16 v[80:81], v12 offset:128
  ds_read_b64_tr_b16 v[82:83], v12 offset:896
  s_waitcnt lgkmcnt(14)
  v_mfma_f32_32x32x16_bf16 v[124:139], v[88:91], v[84:87], v[124:139]
  v_mfma_f32_32x32x16_bf16 v[140:155], v[92:95], v[84:87], v[140:155]
  v_mfma_f32_32x32x16_bf16 v[220:235], v[84:87], v[96:99], v[220:235]
  ds_read_b128 v[84:87], v9 offset:0
  ds_read_b64_tr_b16 v[88:89], v12 offset:3072
  ds_read_b64_tr_b16 v[90:91], v12 offset:3840
  ds_read_b64_tr_b16 v[92:93], v12 offset:3136
  ds_read_b64_tr_b16 v[94:95], v12 offset:3904
  ds_read_b64_tr_b16 v[96:97], v12 offset:3200
  ds_read_b64_tr_b16 v[98:99], v12 offset:3968
  s_waitcnt lgkmcnt(14)
  v_mfma_f32_32x32x16_bf16 v[124:139], v[56:59], v[52:55], v[124:139]
  v_mfma_f32_32x32x16_bf16 v[140:155], v[60:63], v[52:55], v[140:155]
  v_mfma_f32_32x32x16_bf16 v[220:235], v[52:55], v[64:67], v[220:235]
  ds_read_b128 v[52:55], v10 offset:0
  ds_read_b64_tr_b16 v[56:57], v12 offset:6144
  ds_read_b64_tr_b16 v[58:59], v12 offset:6912
  ds_read_b64_tr_b16 v[60:61], v12 offset:6208
  ds_read_b64_tr_b16 v[62:63], v12 offset:6976
  ds_read_b64_tr_b16 v[64:65], v12 offset:6272
  ds_read_b64_tr_b16 v[66:67], v12 offset:7040
  s_waitcnt lgkmcnt(14)
  v_mfma_f32_32x32x16_bf16 v[124:139], v[72:75], v[68:71], v[124:139]
  v_mfma_f32_32x32x16_bf16 v[140:155], v[76:79], v[68:71], v[140:155]
  v_mfma_f32_32x32x16_bf16 v[220:235], v[68:71], v[80:83], v[220:235]
  ds_read_b128 v[68:71], v11 offset:0
  ds_read_b64_tr_b16 v[72:73], v12 offset:9216
  ds_read_b64_tr_b16 v[74:75], v12 offset:9984
  ds_read_b64_tr_b16 v[76:77], v12 offset:9280
  ds_read_b64_tr_b16 v[78:79], v12 offset:10048
  ds_read_b64_tr_b16 v[80:81], v12 offset:9344
  ds_read_b64_tr_b16 v[82:83], v12 offset:10112
  s_waitcnt lgkmcnt(14)
  v_mfma_f32_32x32x16_bf16 v[124:139], v[88:91], v[84:87], v[124:139]
  v_mfma_f32_32x32x16_bf16 v[140:155], v[92:95], v[84:87], v[140:155]
  v_mfma_f32_32x32x16_bf16 v[220:235], v[84:87], v[96:99], v[220:235]
  s_barrier
  ds_read_b128 v[84:87], v8 offset:16384
  ds_read_b64_tr_b16 v[88:89], v12 offset:12288
  ds_read_b64_tr_b16 v[90:91], v12 offset:13056
  ds_read_b64_tr_b16 v[92:93], v12 offset:12352
  ds_read_b64_tr_b16 v[94:95], v12 offset:13120
  ds_read_b64_tr_b16 v[96:97], v12 offset:12416
  ds_read_b64_tr_b16 v[98:99], v12 offset:13184
  s_waitcnt lgkmcnt(14)
  v_mfma_f32_32x32x16_bf16 v[124:139], v[56:59], v[52:55], v[124:139]
  v_mfma_f32_32x32x16_bf16 v[140:155], v[60:63], v[52:55], v[140:155]
  v_mfma_f32_32x32x16_bf16 v[220:235], v[52:55], v[64:67], v[220:235]
  ds_read_b128 v[52:55], v9 offset:16384
  ds_read_b64_tr_b16 v[56:57], v12 offset:15360
  ds_read_b64_tr_b16 v[58:59], v12 offset:16128
  ds_read_b64_tr_b16 v[60:61], v12 offset:15424
  ds_read_b64_tr_b16 v[62:63], v12 offset:16192
  ds_read_b64_tr_b16 v[64:65], v12 offset:15488
  ds_read_b64_tr_b16 v[66:67], v12 offset:16256
  s_waitcnt lgkmcnt(14)
  v_mfma_f32_32x32x16_bf16 v[124:139], v[72:75], v[68:71], v[124:139]
  v_mfma_f32_32x32x16_bf16 v[140:155], v[76:79], v[68:71], v[140:155]
  v_mfma_f32_32x32x16_bf16 v[220:235], v[68:71], v[80:83], v[220:235]
  ds_read_b128 v[68:71], v10 offset:16384
  ds_read_b64_tr_b16 v[72:73], v12 offset:18432
  ds_read_b64_tr_b16 v[74:75], v12 offset:19200
  ds_read_b64_tr_b16 v[76:77], v12 offset:18496
  ds_read_b64_tr_b16 v[78:79], v12 offset:19264
  ds_read_b64_tr_b16 v[80:81], v12 offset:18560
  ds_read_b64_tr_b16 v[82:83], v12 offset:19328
  s_waitcnt lgkmcnt(14)
  v_mfma_f32_32x32x16_bf16 v[124:139], v[88:91], v[84:87], v[124:139]
  v_mfma_f32_32x32x16_bf16 v[140:155], v[92:95], v[84:87], v[140:155]
  v_mfma_f32_32x32x16_bf16 v[220:235], v[84:87], v[96:99], v[220:235]
  ds_read_b128 v[84:87], v11 offset:16384
  ds_read_b64_tr_b16 v[88:89], v12 offset:21504
  ds_read_b64_tr_b16 v[90:91], v12 offset:22272
  ds_read_b64_tr_b16 v[92:93], v12 offset:21568
  ds_read_b64_tr_b16 v[94:95], v12 offset:22336
  ds_read_b64_tr_b16 v[96:97], v12 offset:21632
  ds_read_b64_tr_b16 v[98:99], v12 offset:22400
  s_waitcnt lgkmcnt(14)
  v_mfma_f32_32x32x16_bf16 v[124:139], v[56:59], v[52:55], v[124:139]
  v_mfma_f32_32x32x16_bf16 v[140:155], v[60:63], v[52:55], v[140:155]
  v_mfma_f32_32x32x16_bf16 v[220:235], v[52:55], v[64:67], v[220:235]
  s_barrier
  ds_read_b128 v[52:55], v8 offset:32768
  ds_read_b64_tr_b16 v[56:57], v12 offset:24576
  ds_read_b64_tr_b16 v[58:59], v12 offset:25344
  ds_read_b64_tr_b16 v[60:61], v12 offset:24640
  ds_read_b64_tr_b16 v[62:63], v12 offset:25408
  ds_read_b64_tr_b16 v[64:65], v12 offset:24704
  ds_read_b64_tr_b16 v[66:67], v12 offset:25472
  s_waitcnt lgkmcnt(14)
  v_mfma_f32_32x32x16_bf16 v[124:139], v[72:75], v[68:71], v[124:139]
  v_mfma_f32_32x32x16_bf16 v[140:155], v[76:79], v[68:71], v[140:155]
  v_mfma_f32_32x32x16_bf16 v[220:235], v[68:71], v[80:83], v[220:235]
  ds_read_b128 v[68:71], v9 offset:32768
  ds_read_b64_tr_b16 v[72:73], v12 offset:27648
  ds_read_b64_tr_b16 v[74:75], v12 offset:28416
  ds_read_b64_tr_b16 v[76:77], v12 offset:27712
  ds_read_b64_tr_b16 v[78:79], v12 offset:28480
  ds_read_b64_tr_b16 v[80:81], v12 offset:27776
  ds_read_b64_tr_b16 v[82:83], v12 offset:28544
  s_waitcnt lgkmcnt(14)
  v_mfma_f32_32x32x16_bf16 v[124:139], v[88:91], v[84:87], v[124:139]
  v_mfma_f32_32x32x16_bf16 v[140:155], v[92:95], v[84:87], v[140:155]
  v_mfma_f32_32x32x16_bf16 v[220:235], v[84:87], v[96:99], v[220:235]
  ds_read_b128 v[84:87], v10 offset:32768
  ds_read_b64_tr_b16 v[88:89], v12 offset:30720
  ds_read_b64_tr_b16 v[90:91], v12 offset:31488
  ds_read_b64_tr_b16 v[92:93], v12 offset:30784
  ds_read_b64_tr_b16 v[94:95], v12 offset:31552
  ds_read_b64_tr_b16 v[96:97], v12 offset:30848
  ds_read_b64_tr_b16 v[98:99], v12 offset:31616
  s_waitcnt lgkmcnt(14)
  v_mfma_f32_32x32x16_bf16 v[124:139], v[56:59], v[52:55], v[124:139]
  v_mfma_f32_32x32x16_bf16 v[140:155], v[60:63], v[52:55], v[140:155]
  v_mfma_f32_32x32x16_bf16 v[220:235], v[52:55], v[64:67], v[220:235]
  ds_read_b128 v[52:55], v11 offset:32768
  ds_read_b64_tr_b16 v[56:57], v12 offset:33792
  ds_read_b64_tr_b16 v[58:59], v12 offset:34560
  ds_read_b64_tr_b16 v[60:61], v12 offset:33856
  ds_read_b64_tr_b16 v[62:63], v12 offset:34624
  ds_read_b64_tr_b16 v[64:65], v12 offset:33920
  ds_read_b64_tr_b16 v[66:67], v12 offset:34688
  s_waitcnt lgkmcnt(14)
  v_mfma_f32_32x32x16_bf16 v[124:139], v[72:75], v[68:71], v[124:139]
  v_mfma_f32_32x32x16_bf16 v[140:155], v[76:79], v[68:71], v[140:155]
  v_mfma_f32_32x32x16_bf16 v[220:235], v[68:71], v[80:83], v[220:235]
  s_barrier
  ds_read_b128 v[68:71], v8 offset:49152
  ds_read_b64_tr_b16 v[72:73], v12 offset:36864
  ds_read_b64_tr_b16 v[74:75], v12 offset:37632
  ds_read_b64_tr_b16 v[76:77], v12 offset:36928
  ds_read_b64_tr_b16 v[78:79], v12 offset:37696
  ds_read_b64_tr_b16 v[80:81], v12 offset:36992
  ds_read_b64_tr_b16 v[82:83], v12 offset:37760
  s_waitcnt lgkmcnt(14)
  v_mfma_f32_32x32x16_bf16 v[124:139], v[88:91], v[84:87], v[124:139]
  v_mfma_f32_32x32x16_bf16 v[140:155], v[92:95], v[84:87], v[140:155]
  v_mfma_f32_32x32x16_bf16 v[220:235], v[84:87], v[96:99], v[220:235]
  ds_read_b128 v[84:87], v9 offset:49152
  ds_read_b64_tr_b16 v[88:89], v12 offset:39936
  ds_read_b64_tr_b16 v[90:91], v12 offset:40704
  ds_read_b64_tr_b16 v[92:93], v12 offset:40000
  ds_read_b64_tr_b16 v[94:95], v12 offset:40768
  ds_read_b64_tr_b16 v[96:97], v12 offset:40064
  ds_read_b64_tr_b16 v[98:99], v12 offset:40832
  s_waitcnt lgkmcnt(14)
  v_mfma_f32_32x32x16_bf16 v[124:139], v[56:59], v[52:55], v[124:139]
  v_mfma_f32_32x32x16_bf16 v[140:155], v[60:63], v[52:55], v[140:155]
  v_mfma_f32_32x32x16_bf16 v[220:235], v[52:55], v[64:67], v[220:235]
  ds_read_b128 v[52:55], v10 offset:49152
  ds_read_b64_tr_b16 v[56:57], v12 offset:43008
  ds_read_b64_tr_b16 v[58:59], v12 offset:43776
  ds_read_b64_tr_b16 v[60:61], v12 offset:43072
  ds_read_b64_tr_b16 v[62:63], v12 offset:43840
  ds_read_b64_tr_b16 v[64:65], v12 offset:43136
  ds_read_b64_tr_b16 v[66:67], v12 offset:43904
  s_waitcnt lgkmcnt(14)
  v_mfma_f32_32x32x16_bf16 v[124:139], v[72:75], v[68:71], v[124:139]
  v_mfma_f32_32x32x16_bf16 v[140:155], v[76:79], v[68:71], v[140:155]
  v_mfma_f32_32x32x16_bf16 v[220:235], v[68:71], v[80:83], v[220:235]
  ds_read_b128 v[68:71], v11 offset:49152
  ds_read_b64_tr_b16 v[72:73], v12 offset:46080
  ds_read_b64_tr_b16 v[74:75], v12 offset:46848
  ds_read_b64_tr_b16 v[76:77], v12 offset:46144
  ds_read_b64_tr_b16 v[78:79], v12 offset:46912
  ds_read_b64_tr_b16 v[80:81], v12 offset:46208
  ds_read_b64_tr_b16 v[82:83], v12 offset:46976
  s_waitcnt lgkmcnt(14)
  v_mfma_f32_32x32x16_bf16 v[124:139], v[88:91], v[84:87], v[124:139]
  v_mfma_f32_32x32x16_bf16 v[140:155], v[92:95], v[84:87], v[140:155]
  v_mfma_f32_32x32x16_bf16 v[220:235], v[84:87], v[96:99], v[220:235]
  s_barrier
  ds_read_b128 v[84:87], v8 offset:0
  ds_read_b128 v[88:91], v13 offset:0
  ds_read_b128 v[92:95], v13 offset:4096
  s_waitcnt lgkmcnt(10)
  v_mfma_f32_32x32x16_bf16 v[124:139], v[56:59], v[52:55], v[124:139]
  v_mfma_f32_32x32x16_bf16 v[140:155], v[60:63], v[52:55], v[140:155]
  v_mfma_f32_32x32x16_bf16 v[220:235], v[52:55], v[64:67], v[220:235]
  ds_read_b128 v[52:55], v9 offset:0
  ds_read_b128 v[56:59], v14 offset:0
  ds_read_b128 v[60:63], v14 offset:4096
  s_waitcnt lgkmcnt(6)
  v_mfma_f32_32x32x16_bf16 v[124:139], v[72:75], v[68:71], v[124:139]
  v_mfma_f32_32x32x16_bf16 v[140:155], v[76:79], v[68:71], v[140:155]
  v_mfma_f32_32x32x16_bf16 v[220:235], v[68:71], v[80:83], v[220:235]
  ds_read_b128 v[68:71], v10 offset:0
  ds_read_b128 v[72:75], v15 offset:0
  ds_read_b128 v[76:79], v15 offset:4096
  s_waitcnt lgkmcnt(6)
  v_mfma_f32_32x32x16_bf16 v[20:35], v[84:87], v[88:91], v[20:35]
  v_mfma_f32_32x32x16_bf16 v[36:51], v[84:87], v[92:95], v[36:51]
  s_waitcnt vmcnt(0)
  v_readfirstlane_b32 s24, v116
  s_nop 3
  s_add_u32 s24, s24, 1
  s_xor_b32 s25, s24, 0x5bd1e995
  s_nop 3
  v_cvt_pk_bf16_f32 v140, v140, v141
  v_cvt_pk_bf16_f32 v141, v142, v143
  v_cvt_pk_bf16_f32 v142, v144, v145
  v_cvt_pk_bf16_f32 v143, v146, v147
  v_cvt_pk_bf16_f32 v144, v148, v149
  v_cvt_pk_bf16_f32 v145, v150, v151
  v_cvt_pk_bf16_f32 v146, v152, v153
  v_cvt_pk_bf16_f32 v147, v154, v155
  v_cvt_pk_bf16_f32 v220, v220, v221
  v_cvt_pk_bf16_f32 v221, v222, v223
  v_cvt_pk_bf16_f32 v222, v224, v225
  v_cvt_pk_bf16_f32 v223, v226, v227
  v_cvt_pk_bf16_f32 v224, v228, v229
  v_cvt_pk_bf16_f32 v225, v230, v231
  v_cvt_pk_bf16_f32 v226, v232, v233
  v_cvt_pk_bf16_f32 v227, v234, v235
  buffer_store_dwordx4 v[140:143], v1, s[4:7], s97 offen sc1
  buffer_store_dwordx4 v[220:223], v108, s[4:7], s97 offen offset:1024 sc1
  buffer_store_dwordx4 v[224:227], v108, s[4:7], s97 offen offset:1536 sc1
  buffer_store_dwordx4 v[144:147], v1, s[4:7], s98 offen sc1
  ds_read_b128 v[84:87], v11 offset:0
  ds_read_b128 v[88:91], v16 offset:0
  ds_read_b128 v[92:95], v16 offset:4096
  s_waitcnt lgkmcnt(6)
  v_mfma_f32_32x32x16_bf16 v[20:35], v[52:55], v[56:59], v[20:35]
  v_mfma_f32_32x32x16_bf16 v[36:51], v[52:55], v[60:63], v[36:51]
  ds_write_b128 v109, v[140:143]
  ds_write_b128 v109, v[144:147] offset:8192
  ds_write_b128 v110, v[220:223]
  ds_write_b128 v110, v[224:227] offset:512
  v_pk_mul_f32 v[124:125], v[124:125], s[100:101]
  v_pk_mul_f32 v[126:127], v[126:127], s[100:101]
  v_pk_mul_f32 v[128:129], v[128:129], s[100:101]
  v_pk_mul_f32 v[130:131], v[130:131], s[100:101]
  v_pk_mul_f32 v[132:133], v[132:133], s[100:101]
  v_pk_mul_f32 v[134:135], v[134:135], s[100:101]
  s_barrier
  ds_read_b128 v[52:55], v8 offset:16384
  ds_read_b128 v[56:59], v13 offset:12288
  ds_read_b128 v[60:63], v13 offset:16384
  s_waitcnt lgkmcnt(6)
  v_mfma_f32_32x32x16_bf16 v[20:35], v[68:71], v[72:75], v[20:35]
  v_mfma_f32_32x32x16_bf16 v[36:51], v[68:71], v[76:79], v[36:51]
  v_pk_mul_f32 v[136:137], v[136:137], s[100:101]
  v_pk_mul_f32 v[138:139], v[138:139], s[100:101]
  v_cvt_pk_bf16_f32 v124, v124, v125
  v_cvt_pk_bf16_f32 v125, v126, v127
  v_cvt_pk_bf16_f32 v126, v128, v129
  v_cvt_pk_bf16_f32 v127, v130, v131
  v_cvt_pk_bf16_f32 v128, v132, v133
  v_cvt_pk_bf16_f32 v129, v134, v135
  v_cvt_pk_bf16_f32 v130, v136, v137
  v_cvt_pk_bf16_f32 v131, v138, v139
  ds_read_b128 v[68:71], v9 offset:16384
  ds_read_b128 v[72:75], v14 offset:12288
  ds_read_b128 v[76:79], v14 offset:16384
  s_waitcnt lgkmcnt(6)
  v_mfma_f32_32x32x16_bf16 v[20:35], v[84:87], v[88:91], v[20:35]
  v_mfma_f32_32x32x16_bf16 v[36:51], v[84:87], v[92:95], v[36:51]
  ds_write_b128 v111, v[124:127]
  ds_write_b128 v111, v[128:131] offset:1024
  ds_read_b128 v[84:87], v10 offset:16384
  ds_read_b128 v[88:91], v15 offset:12288
  ds_read_b128 v[92:95], v15 offset:16384
  s_waitcnt lgkmcnt(6)
  v_mfma_f32_32x32x16_bf16 v[20:35], v[52:55], v[56:59], v[20:35]
  v_mfma_f32_32x32x16_bf16 v[36:51], v[52:55], v[60:63], v[36:51]
  ds_read_b128 v[52:55], v11 offset:16384
  ds_read_b128 v[56:59], v16 offset:12288
  ds_read_b128 v[60:63], v16 offset:16384
  s_waitcnt lgkmcnt(6)
  v_mfma_f32_32x32x16_bf16 v[20:35], v[68:71], v[72:75], v[20:35]
  v_mfma_f32_32x32x16_bf16 v[36:51], v[68:71], v[76:79], v[36:51]
  s_barrier
  ds_read_b128 v[68:71], v8 offset:32768
  ds_read_b128 v[72:75], v13 offset:24576
  ds_read_b128 v[76:79], v13 offset:28672
  s_waitcnt lgkmcnt(6)
  v_mfma_f32_32x32x16_bf16 v[20:35], v[84:87], v[88:91], v[20:35]
  v_mfma_f32_32x32x16_bf16 v[36:51], v[84:87], v[92:95], v[36:51]
  ds_read_b128 v[84:87], v9 offset:32768
  ds_read_b128 v[88:91], v14 offset:24576
  ds_read_b128 v[92:95], v14 offset:28672
  s_waitcnt lgkmcnt(6)
  v_mfma_f32_32x32x16_bf16 v[20:35], v[52:55], v[56:59], v[20:35]
  v_mfma_f32_32x32x16_bf16 v[36:51], v[52:55], v[60:63], v[36:51]
  ds_read_b128 v[52:55], v10 offset:32768
  ds_read_b128 v[56:59], v15 offset:24576
  ds_read_b128 v[60:63], v15 offset:28672
  s_waitcnt lgkmcnt(6)
  v_mfma_f32_32x32x16_bf16 v[20:35], v[68:71], v[72:75], v[20:35]
  v_mfma_f32_32x32x16_bf16 v[36:51], v[68:71], v[76:79], v[36:51]
  ds_read_b128 v[68:71], v11 offset:32768
  ds_read_b128 v[72:75], v16 offset:24576
  ds_read_b128 v[76:79], v16 offset:28672
  s_waitcnt lgkmcnt(6)
  v_mfma_f32_32x32x16_bf16 v[20:35], v[84:87], v[88:91], v[20:35]
  v_mfma_f32_32x32x16_bf16 v[36:51], v[84:87], v[92:95], v[36:51]
  s_barrier
  ds_read_b128 v[84:87], v8 offset:49152
  ds_read_b128 v[88:91], v13 offset:36864
  ds_read_b128 v[92:95], v13 offset:40960
  s_waitcnt lgkmcnt(6)
  v_mfma_f32_32x32x16_bf16 v[20:35], v[52:55], v[56:59], v[20:35]
  v_mfma_f32_32x32x16_bf16 v[36:51], v[52:55], v[60:63], v[36:51]
  ds_read_b128 v[52:55], v9 offset:49152
  ds_read_b128 v[56:59], v14 offset:36864
  ds_read_b128 v[60:63], v14 offset:40960
  s_waitcnt lgkmcnt(6)
  v_mfma_f32_32x32x16_bf16 v[20:35], v[68:71], v[72:75], v[20:35]
  v_mfma_f32_32x32x16_bf16 v[36:51], v[68:71], v[76:79], v[36:51]
  ds_read_b128 v[68:71], v10 offset:49152
  ds_read_b128 v[72:75], v15 offset:36864
  ds_read_b128 v[76:79], v15 offset:40960
  s_waitcnt lgkmcnt(6)
  v_mfma_f32_32x32x16_bf16 v[20:35], v[84:87], v[88:91], v[20:35]
  v_mfma_f32_32x32x16_bf16 v[36:51], v[84:87], v[92:95], v[36:51]
  ds_read_b128 v[84:87], v11 offset:49152
  ds_read_b128 v[88:91], v16 offset:36864
  ds_read_b128 v[92:95], v16 offset:40960
  s_waitcnt lgkmcnt(6)
  v_mfma_f32_32x32x16_bf16 v[20:35], v[52:55], v[56:59], v[20:35]
  v_mfma_f32_32x32x16_bf16 v[36:51], v[52:55], v[60:63], v[36:51]
  s_waitcnt vmcnt(0)
  s_barrier
  s_cmp_lg_u32 s30, 0
  s_cbranch_scc1 L_f_nokvflag
  s_lshl_b32 s96, s28, 4
  s_add_u32 s96, s96, s29
  s_lshl_b32 s96, s96, 7
  s_add_u32 s96, s96, 22675456
  s_mov_b64 exec, 1
  v_mov_b32 v104, s24
  v_mov_b32 v105, s25
  v_mov_b32 v106, 0
  buffer_store_dwordx2 v[104:105], v106, s[4:7], s96 offen sc1
  s_mov_b64 exec, -1
L_f_nokvflag:
  ds_read_b128 v[52:55], v8 offset:0
  ds_read_b128 v[56:59], v13 offset:0
  ds_read_b128 v[60:63], v13 offset:4096
  s_waitcnt lgkmcnt(6)
  v_mfma_f32_32x32x16_bf16 v[20:35], v[68:71], v[72:75], v[20:35]
  v_mfma_f32_32x32x16_bf16 v[36:51], v[68:71], v[76:79], v[36:51]
  ds_read_b128 v[68:71], v9 offset:0
  ds_read_b128 v[72:75], v14 offset:0
  ds_read_b128 v[76:79], v14 offset:4096
  s_waitcnt lgkmcnt(6)
  v_mfma_f32_32x32x16_bf16 v[20:35], v[84:87], v[88:91], v[20:35]
  v_mfma_f32_32x32x16_bf16 v[36:51], v[84:87], v[92:95], v[36:51]
  ds_read_b128 v[84:87], v10 offset:0
  ds_read_b128 v[88:91], v15 offset:0
  ds_read_b128 v[92:95], v15 offset:4096
  s_waitcnt lgkmcnt(6)
  v_mfma_f32_32x32x16_bf16 v[20:35], v[52:55], v[56:59], v[20:35]
  v_mfma_f32_32x32x16_bf16 v[36:51], v[52:55], v[60:63], v[36:51]
  ds_read_b128 v[52:55], v11 offset:0
  ds_read_b128 v[56:59], v16 offset:0
  ds_read_b128 v[60:63], v16 offset:4096
  s_waitcnt lgkmcnt(6)
  v_mfma_f32_32x32x16_bf16 v[20:35], v[68:71], v[72:75], v[20:35]
  v_mfma_f32_32x32x16_bf16 v[36:51], v[68:71], v[76:79], v[36:51]
  s_barrier
  ds_read_b128 v[68:71], v8 offset:16384
  ds_read_b128 v[72:75], v13 offset:12288
  ds_read_b128 v[76:79], v13 offset:16384
  s_waitcnt lgkmcnt(6)
  v_mfma_f32_32x32x16_bf16 v[20:35], v[84:87], v[88:91], v[20:35]
  v_mfma_f32_32x32x16_bf16 v[36:51], v[84:87], v[92:95], v[36:51]
  ds_read_b128 v[84:87], v9 offset:16384
  ds_read_b128 v[88:91], v14 offset:12288
  ds_read_b128 v[92:95], v14 offset:16384
  s_waitcnt lgkmcnt(6)
  v_mfma_f32_32x32x16_bf16 v[20:35], v[52:55], v[56:59], v[20:35]
  v_mfma_f32_32x32x16_bf16 v[36:51], v[52:55], v[60:63], v[36:51]
  ds_read_b128 v[52:55], v10 offset:16384
  ds_read_b128 v[56:59], v15 offset:12288
  ds_read_b128 v[60:63], v15 offset:16384
  s_waitcnt lgkmcnt(6)
  v_mfma_f32_32x32x16_bf16 v[20:35], v[68:71], v[72:75], v[20:35]
  v_mfma_f32_32x32x16_bf16 v[36:51], v[68:71], v[76:79], v[36:51]
  ds_read_b128 v[68:71], v11 offset:16384
  ds_read_b128 v[72:75], v16 offset:12288
  ds_read_b128 v[76:79], v16 offset:16384
  s_waitcnt lgkmcnt(6)
  v_mfma_f32_32x32x16_bf16 v[20:35], v[84:87], v[88:91], v[20:35]
  v_mfma_f32_32x32x16_bf16 v[36:51], v[84:87], v[92:95], v[36:51]
  s_barrier
  ds_read_b128 v[84:87], v8 offset:32768
  ds_read_b128 v[88:91], v13 offset:24576
  ds_read_b128 v[92:95], v13 offset:28672
  s_waitcnt lgkmcnt(6)
  v_mfma_f32_32x32x16_bf16 v[20:35], v[52:55], v[56:59], v[20:35]
  v_mfma_f32_32x32x16_bf16 v[36:51], v[52:55], v[60:63], v[36:51]
  ds_read_b128 v[52:55], v9 offset:32768
  ds_read_b128 v[56:59], v14 offset:24576
  ds_read_b128 v[60:63], v14 offset:28672
  s_waitcnt lgkmcnt(6)
  v_mfma_f32_32x32x16_bf16 v[20:35], v[68:71], v[72:75], v[20:35]
  v_mfma_f32_32x32x16_bf16 v[36:51], v[68:71], v[76:79], v[36:51]
  ds_read_b128 v[68:71], v10 offset:32768
  ds_read_b128 v[72:75], v15 offset:24576
  ds_read_b128 v[76:79], v15 offset:28672
  s_waitcnt lgkmcnt(6)
  v_mfma_f32_32x32x16_bf16 v[20:35], v[84:87], v[88:91], v[20:35]
  v_mfma_f32_32x32x16_bf16 v[36:51], v[84:87], v[92:95], v[36:51]
  v_lshlrev_b32 v103, 7, v0
  s_lshl_b32 s96, s28, 11
  s_add_u32 s96, s96, 22675456
  s_mov_b32 exec_lo, 0x0000ffff
  s_mov_b32 exec_hi, 0
  buffer_load_dwordx2 v[104:105], v103, s[4:7], s96 offen sc1
  s_mov_b64 exec, -1
  ds_read_b128 v[84:87], v11 offset:32768
  ds_read_b128 v[88:91], v16 offset:24576
  ds_read_b128 v[92:95], v16 offset:28672
  s_waitcnt lgkmcnt(6)
  v_mfma_f32_32x32x16_bf16 v[20:35], v[52:55], v[56:59], v[20:35]
  v_mfma_f32_32x32x16_bf16 v[36:51], v[52:55], v[60:63], v[36:51]
  s_barrier
  ds_read_b128 v[52:55], v8 offset:49152
  ds_read_b128 v[56:59], v13 offset:36864
  ds_read_b128 v[60:63], v13 offset:40960
  s_waitcnt lgkmcnt(6)
  v_mfma_f32_32x32x16_bf16 v[20:35], v[68:71], v[72:75], v[20:35]
  v_mfma_f32_32x32x16_bf16 v[36:51], v[68:71], v[76:79], v[36:51]
  ds_read_b128 v[68:71], v9 offset:49152
  ds_read_b128 v[72:75], v14 offset:36864
  ds_read_b128 v[76:79], v14 offset:40960
  s_waitcnt lgkmcnt(6)
  v_mfma_f32_32x32x16_bf16 v[20:35], v[84:87], v[88:91], v[20:35]
  v_mfma_f32_32x32x16_bf16 v[36:51], v[84:87], v[92:95], v[36:51]
  ds_read_b128 v[84:87], v10 offset:49152
  ds_read_b128 v[88:91], v15 offset:36864
  ds_read_b128 v[92:95], v15 offset:40960
  s_waitcnt lgkmcnt(6)
  v_mfma_f32_32x32x16_bf16 v[20:35], v[52:55], v[56:59], v[20:35]
  v_mfma_f32_32x32x16_bf16 v[36:51], v[52:55], v[60:63], v[36:51]
  ds_read_b128 v[52:55], v11 offset:49152
  ds_read_b128 v[56:59], v16 offset:36864
  ds_read_b128 v[60:63], v16 offset:40960
  s_waitcnt lgkmcnt(6)
  v_mfma_f32_32x32x16_bf16 v[20:35], v[68:71], v[72:75], v[20:35]
  v_mfma_f32_32x32x16_bf16 v[36:51], v[68:71], v[76:79], v[36:51]
  s_waitcnt lgkmcnt(3)
  v_mfma_f32_32x32x16_bf16 v[20:35], v[84:87], v[88:91], v[20:35]
  v_mfma_f32_32x32x16_bf16 v[36:51], v[84:87], v[92:95], v[36:51]
  s_waitcnt vmcnt(0)
  s_mov_b32 exec_lo, 0x0000ffff
  s_mov_b32 exec_hi, 0
  v_cmp_ne_u32 vcc, s24, v104
  v_cmp_ne_u32 s[36:37], s25, v105
  s_or_b64 vcc, vcc, s[36:37]
  s_mov_b64 exec, -1
  s_cbranch_vccnz L_f_remote_done_a
  s_mov_b32 s55, 1
  buffer_load_dwordx4 v[132:135], v3, s[4:7], s38 offen offset:0 sc1
  s_mov_b64 exec, s[40:41]
  buffer_load_dwordx4 v[172:175], v2, s[4:7], s38 offen offset:1024 sc1
  buffer_load_dwordx4 v[176:179], v2, s[4:7], s38 offen offset:1536 sc1
  s_mov_b64 exec, -1
  buffer_load_dwordx4 v[136:139], v3, s[4:7], s38 offen offset:2048 sc1
  s_mov_b64 exec, s[40:41]
  buffer_load_dwordx4 v[180:183], v2, s[4:7], s38 offen offset:3072 sc1
  buffer_load_dwordx4 v[184:187], v2, s[4:7], s38 offen offset:3584 sc1
  s_mov_b64 exec, -1
  s_add_u32 s38, s38, 8192
  s_and_b32 s38, s38, 0x1ffff
  buffer_load_dwordx4 v[140:143], v3, s[4:7], s38 offen offset:0 sc1
  s_mov_b64 exec, s[40:41]
  buffer_load_dwordx4 v[188:191], v2, s[4:7], s38 offen offset:1024 sc1
  buffer_load_dwordx4 v[192:195], v2, s[4:7], s38 offen offset:1536 sc1
  s_mov_b64 exec, -1
  buffer_load_dwordx4 v[144:147], v3, s[4:7], s38 offen offset:2048 sc1
  s_mov_b64 exec, s[40:41]
  buffer_load_dwordx4 v[196:199], v2, s[4:7], s38 offen offset:3072 sc1
  buffer_load_dwordx4 v[200:203], v2, s[4:7], s38 offen offset:3584 sc1
  s_mov_b64 exec, -1
  s_add_u32 s38, s38, 8192
  s_and_b32 s38, s38, 0x1ffff
  buffer_load_dwordx4 v[148:151], v3, s[4:7], s38 offen offset:0 sc1
  s_mov_b64 exec, s[40:41]
  buffer_load_dwordx4 v[204:207], v2, s[4:7], s38 offen offset:1024 sc1
  buffer_load_dwordx4 v[208:211], v2, s[4:7], s38 offen offset:1536 sc1
  s_mov_b64 exec, -1
L_f_remote_done_a:
  s_waitcnt lgkmcnt(0)
  v_mfma_f32_32x32x16_bf16 v[20:35], v[52:55], v[56:59], v[20:35]
  v_mfma_f32_32x32x16_bf16 v[36:51], v[52:55], v[60:63], v[36:51]
  s_nop 15
  v_and_b32 v100, 31, v0
  v_lshrrev_b32 v101, 5, v0
  s_lshl_b32 s36, s31, 1
  v_add_u32 v101, s36, v101
  v_lshl_add_u32 v101, v101, 5, v100
  v_lshlrev_b32 v101, 7, v101
  v_and_b32 v102, 3, v0
  v_xor_b32 v103, 0, v102
  v_lshl_add_u32 v103, v103, 4, v101
  ds_write_b128 v103, v[20:23] offset:0
  ds_write_b128 v103, v[36:39] offset:64
  v_xor_b32 v103, 1, v102
  v_lshl_add_u32 v103, v103, 4, v101
  ds_write_b128 v103, v[24:27] offset:0
  ds_write_b128 v103, v[40:43] offset:64
  v_xor_b32 v103, 2, v102
  v_lshl_add_u32 v103, v103, 4, v101
  ds_write_b128 v103, v[28:31] offset:0
  ds_write_b128 v103, v[44:47] offset:64
  v_xor_b32 v103, 3, v102
  v_lshl_add_u32 v103, v103, 4, v101
  ds_write_b128 v103, v[32:35] offset:0
  ds_write_b128 v103, v[48:51] offset:64
  s_waitcnt lgkmcnt(0)
  s_barrier
  s_bfe_u32 s36, s30, 0x10001
  s_lshl_b32 s37, s36, 10
  s_add_u32 s37, s37, 114688
  s_lshl_b32 s96, s33, 12
  s_add_u32 s97, s37, s96
  s_sub_u32 s37, s37, s96
  s_add_u32 s37, s37, 4096
  v_add_u32 v100, s97, v1
  v_add_u32 v102, s37, v1
  ds_read_b128 v[4:7], v100 offset:0
  ds_read_b128 v[8:11], v100 offset:2048
  ds_read_b128 v[12:15], v102 offset:0
  ds_read_b128 v[16:19], v102 offset:2048
  s_lshl_b32 s36, s36, 13
  s_lshl_b32 s37, s33, 12
  s_add_u32 s36, s36, s37
  s_add_u32 s36, s36, 122880
  v_add_u32 v100, s36, v1
  v_add_u32 v101, s36, v112
  ds_read_b128 v[124:127], v100 offset:0
  ds_read_b128 v[128:131], v100 offset:2048
  s_mov_b64 exec, s[40:41]
  ds_read_b128 v[156:159], v101 offset:1024
  ds_read_b128 v[160:163], v101 offset:1536
  ds_read_b128 v[164:167], v101 offset:3072
  ds_read_b128 v[168:171], v101 offset:3584
  s_mov_b64 exec, -1
  v_mov_b32 v20, 0
  v_mov_b32 v21, 0
  v_mov_b32 v22, 0
  v_mov_b32 v23, 0
  v_mov_b32 v24, 0
  v_mov_b32 v25, 0
  v_mov_b32 v26, 0
  v_mov_b32 v27, 0
  v_mov_b32 v28, 0
  v_mov_b32 v29, 0
  v_mov_b32 v30, 0
  v_mov_b32 v31, 0
  v_mov_b32 v32, 0
  v_mov_b32 v33, 0
  v_mov_b32 v34, 0
  v_mov_b32 v35, 0
  v_mov_b32 v36, 0
  v_mov_b32 v37, 0
  v_mov_b32 v38, 0
  v_mov_b32 v39, 0
  v_mov_b32 v40, 0
  v_mov_b32 v41, 0
  v_mov_b32 v42, 0
  v_mov_b32 v43, 0
  v_mov_b32 v44, 0
  v_mov_b32 v45, 0
  v_mov_b32 v46, 0
  v_mov_b32 v47, 0
  v_mov_b32 v48, 0
  v_mov_b32 v49, 0
  v_mov_b32 v50, 0
  v_mov_b32 v51, 0
  v_mov_b32 v52, 0
  v_mov_b32 v53, 0
  v_mov_b32 v54, 0
  v_mov_b32 v55, 0
  v_mov_b32 v56, 0
  v_mov_b32 v57, 0
  v_mov_b32 v58, 0
  v_mov_b32 v59, 0
  v_mov_b32 v60, 0
  v_mov_b32 v61, 0
  v_mov_b32 v62, 0
  v_mov_b32 v63, 0
  v_mov_b32 v64, 0
  v_mov_b32 v65, 0
  v_mov_b32 v66, 0
  v_mov_b32 v67, 0
  v_mov_b32 v68, 0
  v_mov_b32 v69, 0
  v_mov_b32 v70, 0
  v_mov_b32 v71, 0
  v_mov_b32 v72, 0
  v_mov_b32 v73, 0
  v_mov_b32 v74, 0
  v_mov_b32 v75, 0
  v_mov_b32 v76, 0
  v_mov_b32 v77, 0
  v_mov_b32 v78, 0
  v_mov_b32 v79, 0
  v_mov_b32 v80, 0
  v_mov_b32 v81, 0
  v_mov_b32 v82, 0
  v_mov_b32 v83, 0
  v_mov_b32 v120, 0
  v_mov_b32 v121, 0
  v_mov_b32 v112, 0
  v_mov_b32 v113, 0
  v_mov_b32 v114, 0
  v_mov_b32 v115, 0
  s_cmp_lg_u32 s55, 0
  s_cbranch_scc1 L_f_remote_done_b
  v_lshlrev_b32 v103, 7, v0
  s_lshl_b32 s96, s28, 11
  s_add_u32 s96, s96, 22675456
  s_mov_b32 exec_lo, 0x0000ffff
  s_mov_b32 exec_hi, 0
  s_mov_b32 s26, 400000
L_poll_kv:
  buffer_load_dwordx2 v[104:105], v103, s[4:7], s96 offen sc1
  s_waitcnt vmcnt(0)
  v_cmp_ne_u32 vcc, s24, v104
  v_cmp_ne_u32 s[36:37], s25, v105
  s_or_b64 vcc, vcc, s[36:37]
  s_cbranch_vccz L_polld_kv
  s_sub_u32 s26, s26, 1
  s_cbranch_scc1 L_polld_kv
  s_sleep 1
  s_branch L_poll_kv
L_polld_kv:
  s_mov_b64 exec, -1
  buffer_load_dwordx4 v[132:135], v3, s[4:7], s38 offen offset:0 sc1
  s_mov_b64 exec, s[40:41]
  buffer_load_dwordx4 v[172:175], v2, s[4:7], s38 offen offset:1024 sc1
  buffer_load_dwordx4 v[176:179], v2, s[4:7], s38 offen offset:1536 sc1
  s_mov_b64 exec, -1
  buffer_load_dwordx4 v[136:139], v3, s[4:7], s38 offen offset:2048 sc1
  s_mov_b64 exec, s[40:41]
  buffer_load_dwordx4 v[180:183], v2, s[4:7], s38 offen offset:3072 sc1
  buffer_load_dwordx4 v[184:187], v2, s[4:7], s38 offen offset:3584 sc1
  s_mov_b64 exec, -1
  s_add_u32 s38, s38, 8192
  s_and_b32 s38, s38, 0x1ffff
  buffer_load_dwordx4 v[140:143], v3, s[4:7], s38 offen offset:0 sc1
  s_mov_b64 exec, s[40:41]
  buffer_load_dwordx4 v[188:191], v2, s[4:7], s38 offen offset:1024 sc1
  buffer_load_dwordx4 v[192:195], v2, s[4:7], s38 offen offset:1536 sc1
  s_mov_b64 exec, -1
  buffer_load_dwordx4 v[144:147], v3, s[4:7], s38 offen offset:2048 sc1
  s_mov_b64 exec, s[40:41]
  buffer_load_dwordx4 v[196:199], v2, s[4:7], s38 offen offset:3072 sc1
  buffer_load_dwordx4 v[200:203], v2, s[4:7], s38 offen offset:3584 sc1
  s_mov_b64 exec, -1
  s_add_u32 s38, s38, 8192
  s_and_b32 s38, s38, 0x1ffff
  buffer_load_dwordx4 v[148:151], v3, s[4:7], s38 offen offset:0 sc1
  s_mov_b64 exec, s[40:41]
  buffer_load_dwordx4 v[204:207], v2, s[4:7], s38 offen offset:1024 sc1
  buffer_load_dwordx4 v[208:211], v2, s[4:7], s38 offen offset:1536 sc1
  s_mov_b64 exec, -1
L_f_remote_done_b:
  s_waitcnt lgkmcnt(0)
  v_mfma_f32_32x32x16_bf16 v[84:99], v[124:127], v[4:7], 0
  s_mov_b32 s27, 3
  s_nop 11
  v_exp_f32 v84, v84
  v_cvt_pk_bf16_f32 v122, v112, v113
  v_exp_f32 v85, v85
  v_cvt_pk_bf16_f32 v123, v114, v115
  v_exp_f32 v86, v86
  v_exp_f32 v87, v87
L_at_loop_f:
  v_mfma_f32_32x32x16_bf16 v[68:83], v[216:219], v[120:123], v[68:83]
  buffer_load_dwordx4 v[152:155], v3, s[4:7], s38 offen offset:2048 sc1
  s_mov_b64 exec, s[40:41]
  buffer_load_dwordx4 v[212:215], v2, s[4:7], s38 offen offset:3072 sc1
  buffer_load_dwordx4 v[216:219], v2, s[4:7], s38 offen offset:3584 sc1
  s_mov_b64 exec, -1
  s_add_u32 s38, s38, 8192
  s_and_b32 s38, s38, 0x1ffff
  v_cvt_pk_bf16_f32 v116, v84, v85
  v_exp_f32 v88, v88
  v_exp_f32 v89, v89
  v_cvt_pk_bf16_f32 v117, v86, v87
  v_mfma_f32_32x32x16_bf16 v[100:115], v[124:127], v[8:11], 0
  v_exp_f32 v90, v90
  v_exp_f32 v91, v91
  v_cvt_pk_bf16_f32 v118, v88, v89
  v_exp_f32 v92, v92
  v_exp_f32 v93, v93
  v_cvt_pk_bf16_f32 v119, v90, v91
  v_exp_f32 v94, v94
  v_exp_f32 v95, v95
  v_mfma_f32_32x32x16_bf16 v[20:35], v[156:159], v[116:119], v[20:35]
  v_cvt_pk_bf16_f32 v120, v92, v93
  v_exp_f32 v96, v96
  v_exp_f32 v97, v97
  v_cvt_pk_bf16_f32 v121, v94, v95
  v_exp_f32 v98, v98
  v_exp_f32 v99, v99
  v_exp_f32 v100, v100
  v_cvt_pk_bf16_f32 v122, v96, v97
  v_exp_f32 v101, v101
  v_cvt_pk_bf16_f32 v123, v98, v99
  v_exp_f32 v102, v102
  v_exp_f32 v103, v103
  v_mfma_f32_32x32x16_bf16 v[20:35], v[160:163], v[120:123], v[20:35]
  v_cvt_pk_bf16_f32 v116, v100, v101
  v_exp_f32 v104, v104
  v_exp_f32 v105, v105
  v_cvt_pk_bf16_f32 v117, v102, v103
  v_mfma_f32_32x32x16_bf16 v[84:99], v[124:127], v[12:15], 0
  v_exp_f32 v106, v106
  v_exp_f32 v107, v107
  v_cvt_pk_bf16_f32 v118, v104, v105
  v_exp_f32 v108, v108
  v_exp_f32 v109, v109
  v_cvt_pk_bf16_f32 v119, v106, v107
  v_exp_f32 v110, v110
  v_exp_f32 v111, v111
  v_mfma_f32_32x32x16_bf16 v[36:51], v[156:159], v[116:119], v[36:51]
  v_cvt_pk_bf16_f32 v120, v108, v109
  v_exp_f32 v112, v112
  v_exp_f32 v113, v113
  v_cvt_pk_bf16_f32 v121, v110, v111
  v_exp_f32 v114, v114
  v_exp_f32 v115, v115
  v_exp_f32 v84, v84
  v_cvt_pk_bf16_f32 v122, v112, v113
  v_exp_f32 v85, v85
  v_cvt_pk_bf16_f32 v123, v114, v115
  v_exp_f32 v86, v86
  v_exp_f32 v87, v87
  v_mfma_f32_32x32x16_bf16 v[36:51], v[160:163], v[120:123], v[36:51]
  v_cvt_pk_bf16_f32 v116, v84, v85
  v_exp_f32 v88, v88
  v_exp_f32 v89, v89
  v_cvt_pk_bf16_f32 v117, v86, v87
  v_mfma_f32_32x32x16_bf16 v[100:115], v[124:127], v[16:19], 0
  v_exp_f32 v90, v90
  v_exp_f32 v91, v91
  v_cvt_pk_bf16_f32 v118, v88, v89
  v_exp_f32 v92, v92
  v_exp_f32 v93, v93
  v_cvt_pk_bf16_f32 v119, v90, v91
  v_exp_f32 v94, v94
  v_exp_f32 v95, v95
  v_mfma_f32_32x32x16_bf16 v[52:67], v[156:159], v[116:119], v[52:67]
  v_cvt_pk_bf16_f32 v120, v92, v93
  v_exp_f32 v96, v96
  v_exp_f32 v97, v97
  v_cvt_pk_bf16_f32 v121, v94, v95
  v_exp_f32 v98, v98
  v_exp_f32 v99, v99
  v_exp_f32 v100, v100
  v_cvt_pk_bf16_f32 v122, v96, v97
  v_exp_f32 v101, v101
  v_cvt_pk_bf16_f32 v123, v98, v99
  v_exp_f32 v102, v102
  v_exp_f32 v103, v103
  v_mfma_f32_32x32x16_bf16 v[52:67], v[160:163], v[120:123], v[52:67]
  v_cvt_pk_bf16_f32 v116, v100, v101
  v_exp_f32 v104, v104
  v_exp_f32 v105, v105
  v_cvt_pk_bf16_f32 v117, v102, v103
  s_waitcnt vmcnt(18)
  v_mfma_f32_32x32x16_bf16 v[84:99], v[128:131], v[4:7], 0
  v_exp_f32 v106, v106
  v_exp_f32 v107, v107
  v_cvt_pk_bf16_f32 v118, v104, v105
  v_exp_f32 v108, v108
  v_exp_f32 v109, v109
  v_cvt_pk_bf16_f32 v119, v106, v107
  v_exp_f32 v110, v110
  v_exp_f32 v111, v111
  v_mfma_f32_32x32x16_bf16 v[68:83], v[156:159], v[116:119], v[68:83]
  v_cvt_pk_bf16_f32 v120, v108, v109
  v_exp_f32 v112, v112
  v_exp_f32 v113, v113
  v_cvt_pk_bf16_f32 v121, v110, v111
  v_exp_f32 v114, v114
  v_exp_f32 v115, v115
  v_exp_f32 v84, v84
  v_cvt_pk_bf16_f32 v122, v112, v113
  v_exp_f32 v85, v85
  v_cvt_pk_bf16_f32 v123, v114, v115
  v_exp_f32 v86, v86
  v_exp_f32 v87, v87
  v_mfma_f32_32x32x16_bf16 v[68:83], v[160:163], v[120:123], v[68:83]
  buffer_load_dwordx4 v[124:127], v3, s[4:7], s38 offen offset:0 sc1
  s_mov_b64 exec, s[40:41]
  buffer_load_dwordx4 v[156:159], v2, s[4:7], s38 offen offset:1024 sc1
  buffer_load_dwordx4 v[160:163], v2, s[4:7], s38 offen offset:1536 sc1
  s_mov_b64 exec, -1
  v_cvt_pk_bf16_f32 v116, v84, v85
  v_exp_f32 v88, v88
  v_exp_f32 v89, v89
  v_cvt_pk_bf16_f32 v117, v86, v87
  v_mfma_f32_32x32x16_bf16 v[100:115], v[128:131], v[8:11], 0
  v_exp_f32 v90, v90
  v_exp_f32 v91, v91
  v_cvt_pk_bf16_f32 v118, v88, v89
  v_exp_f32 v92, v92
  v_exp_f32 v93, v93
  v_cvt_pk_bf16_f32 v119, v90, v91
  v_exp_f32 v94, v94
  v_exp_f32 v95, v95
  v_mfma_f32_32x32x16_bf16 v[20:35], v[164:167], v[116:119], v[20:35]
  v_cvt_pk_bf16_f32 v120, v92, v93
  v_exp_f32 v96, v96
  v_exp_f32 v97, v97
  v_cvt_pk_bf16_f32 v121, v94, v95
  v_exp_f32 v98, v98
  v_exp_f32 v99, v99
  v_exp_f32 v100, v100
  v_cvt_pk_bf16_f32 v122, v96, v97
  v_exp_f32 v101, v101
  v_cvt_pk_bf16_f32 v123, v98, v99
  v_exp_f32 v102, v102
  v_exp_f32 v103, v103
  v_mfma_f32_32x32x16_bf16 v[20:35], v[168:171], v[120:123], v[20:35]
  v_cvt_pk_bf16_f32 v116, v100, v101
  v_exp_f32 v104, v104
  v_exp_f32 v105, v105
  v_cvt_pk_bf16_f32 v117, v102, v103
  v_mfma_f32_32x32x16_bf16 v[84:99], v[128:131], v[12:15], 0
  v_exp_f32 v106, v106
  v_exp_f32 v107, v107
  v_cvt_pk_bf16_f32 v118, v104, v105
  v_exp_f32 v108, v108
  v_exp_f32 v109, v109
  v_cvt_pk_bf16_f32 v119, v106, v107
  v_exp_f32 v110, v110
  v_exp_f32 v111, v111
  v_mfma_f32_32x32x16_bf16 v[36:51], v[164:167], v[116:119], v[36:51]
  v_cvt_pk_bf16_f32 v120, v108, v109
  v_exp_f32 v112, v112
  v_exp_f32 v113, v113
  v_cvt_pk_bf16_f32 v121, v110, v111
  v_exp_f32 v114, v114
  v_exp_f32 v115, v115
  v_exp_f32 v84, v84
  v_cvt_pk_bf16_f32 v122, v112, v113
  v_exp_f32 v85, v85
  v_cvt_pk_bf16_f32 v123, v114, v115
  v_exp_f32 v86, v86
  v_exp_f32 v87, v87
  v_mfma_f32_32x32x16_bf16 v[36:51], v[168:171], v[120:123], v[36:51]
  v_cvt_pk_bf16_f32 v116, v84, v85
  v_exp_f32 v88, v88
  v_exp_f32 v89, v89
  v_cvt_pk_bf16_f32 v117, v86, v87
  v_mfma_f32_32x32x16_bf16 v[100:115], v[128:131], v[16:19], 0
  v_exp_f32 v90, v90
  v_exp_f32 v91, v91
  v_cvt_pk_bf16_f32 v118, v88, v89
  v_exp_f32 v92, v92
  v_exp_f32 v93, v93
  v_cvt_pk_bf16_f32 v119, v90, v91
  v_exp_f32 v94, v94
  v_exp_f32 v95, v95
  v_mfma_f32_32x32x16_bf16 v[52:67], v[164:167], v[116:119], v[52:67]
  v_cvt_pk_bf16_f32 v120, v92, v93
  v_exp_f32 v96, v96
  v_exp_f32 v97, v97
  v_cvt_pk_bf16_f32 v121, v94, v95
  v_exp_f32 v98, v98
  v_exp_f32 v99, v99
  v_exp_f32 v100, v100
  v_cvt_pk_bf16_f32 v122, v96, v97
  v_exp_f32 v101, v101
  v_cvt_pk_bf16_f32 v123, v98, v99
  v_exp_f32 v102, v102
  v_exp_f32 v103, v103
  v_mfma_f32_32x32x16_bf16 v[52:67], v[168:171], v[120:123], v[52:67]
  v_cvt_pk_bf16_f32 v116, v100, v101
  v_exp_f32 v104, v104
  v_exp_f32 v105, v105
  v_cvt_pk_bf16_f32 v117, v102, v103
  s_waitcnt vmcnt(18)
  v_mfma_f32_32x32x16_bf16 v[84:99], v[132:135], v[4:7], 0
  v_exp_f32 v106, v106
  v_exp_f32 v107, v107
  v_cvt_pk_bf16_f32 v118, v104, v105
  v_exp_f32 v108, v108
  v_exp_f32 v109, v109
  v_cvt_pk_bf16_f32 v119, v106, v107
  v_exp_f32 v110, v110
  v_exp_f32 v111, v111
  v_mfma_f32_32x32x16_bf16 v[68:83], v[164:167], v[116:119], v[68:83]
  v_cvt_pk_bf16_f32 v120, v108, v109
  v_exp_f32 v112, v112
  v_exp_f32 v113, v113
  v_cvt_pk_bf16_f32 v121, v110, v111
  v_exp_f32 v114, v114
  v_exp_f32 v115, v115
  v_exp_f32 v84, v84
  v_cvt_pk_bf16_f32 v122, v112, v113
  v_exp_f32 v85, v85
  v_cvt_pk_bf16_f32 v123, v114, v115
  v_exp_f32 v86, v86
  v_exp_f32 v87, v87
  v_mfma_f32_32x32x16_bf16 v[68:83], v[168:171], v[120:123], v[68:83]
  buffer_load_dwordx4 v[128:131], v3, s[4:7], s38 offen offset:2048 sc1
  s_mov_b64 exec, s[40:41]
  buffer_load_dwordx4 v[164:167], v2, s[4:7], s38 offen offset:3072 sc1
  buffer_load_dwordx4 v[168:171], v2, s[4:7], s38 offen offset:3584 sc1
  s_mov_b64 exec, -1
  s_add_u32 s38, s38, 8192
  s_and_b32 s38, s38, 0x1ffff
  v_cvt_pk_bf16_f32 v116, v84, v85
  v_exp_f32 v88, v88
  v_exp_f32 v89, v89
  v_cvt_pk_bf16_f32 v117, v86, v87
  v_mfma_f32_32x32x16_bf16 v[100:115], v[132:135], v[8:11], 0
  v_exp_f32 v90, v90
  v_exp_f32 v91, v91
  v_cvt_pk_bf16_f32 v118, v88, v89
  v_exp_f32 v92, v92
  v_exp_f32 v93, v93
  v_cvt_pk_bf16_f32 v119, v90, v91
  v_exp_f32 v94, v94
  v_exp_f32 v95, v95
  v_mfma_f32_32x32x16_bf16 v[20:35], v[172:175], v[116:119], v[20:35]
  v_cvt_pk_bf16_f32 v120, v92, v93
  v_exp_f32 v96, v96
  v_exp_f32 v97, v97
  v_cvt_pk_bf16_f32 v121, v94, v95
  v_exp_f32 v98, v98
  v_exp_f32 v99, v99
  v_exp_f32 v100, v100
  v_cvt_pk_bf16_f32 v122, v96, v97
  v_exp_f32 v101, v101
  v_cvt_pk_bf16_f32 v123, v98, v99
  v_exp_f32 v102, v102
  v_exp_f32 v103, v103
  v_mfma_f32_32x32x16_bf16 v[20:35], v[176:179], v[120:123], v[20:35]
  v_cvt_pk_bf16_f32 v116, v100, v101
  v_exp_f32 v104, v104
  v_exp_f32 v105, v105
  v_cvt_pk_bf16_f32 v117, v102, v103
  v_mfma_f32_32x32x16_bf16 v[84:99], v[132:135], v[12:15], 0
  v_exp_f32 v106, v106
  v_exp_f32 v107, v107
  v_cvt_pk_bf16_f32 v118, v104, v105
  v_exp_f32 v108, v108
  v_exp_f32 v109, v109
  v_cvt_pk_bf16_f32 v119, v106, v107
  v_exp_f32 v110, v110
  v_exp_f32 v111, v111
  v_mfma_f32_32x32x16_bf16 v[36:51], v[172:175], v[116:119], v[36:51]
  v_cvt_pk_bf16_f32 v120, v108, v109
  v_exp_f32 v112, v112
  v_exp_f32 v113, v113
  v_cvt_pk_bf16_f32 v121, v110, v111
  v_exp_f32 v114, v114
  v_exp_f32 v115, v115
  v_exp_f32 v84, v84
  v_cvt_pk_bf16_f32 v122, v112, v113
  v_exp_f32 v85, v85
  v_cvt_pk_bf16_f32 v123, v114, v115
  v_exp_f32 v86, v86
  v_exp_f32 v87, v87
  v_mfma_f32_32x32x16_bf16 v[36:51], v[176:179], v[120:123], v[36:51]
  v_cvt_pk_bf16_f32 v116, v84, v85
  v_exp_f32 v88, v88
  v_exp_f32 v89, v89
  v_cvt_pk_bf16_f32 v117, v86, v87
  v_mfma_f32_32x32x16_bf16 v[100:115], v[132:135], v[16:19], 0
  v_exp_f32 v90, v90
  v_exp_f32 v91, v91
  v_cvt_pk_bf16_f32 v118, v88, v89
  v_exp_f32 v92, v92
  v_exp_f32 v93, v93
  v_cvt_pk_bf16_f32 v119, v90, v91
  v_exp_f32 v94, v94
  v_exp_f32 v95, v95
  v_mfma_f32_32x32x16_bf16 v[52:67], v[172:175], v[116:119], v[52:67]
  v_cvt_pk_bf16_f32 v120, v92, v93
  v_exp_f32 v96, v96
  v_exp_f32 v97, v97
  v_cvt_pk_bf16_f32 v121, v94, v95
  v_exp_f32 v98, v98
  v_exp_f32 v99, v99
  v_exp_f32 v100, v100
  v_cvt_pk_bf16_f32 v122, v96, v97
  v_exp_f32 v101, v101
  v_cvt_pk_bf16_f32 v123, v98, v99
  v_exp_f32 v102, v102
  v_exp_f32 v103, v103
  v_mfma_f32_32x32x16_bf16 v[52:67], v[176:179], v[120:123], v[52:67]
  v_cvt_pk_bf16_f32 v116, v100, v101
  v_exp_f32 v104, v104
  v_exp_f32 v105, v105
  v_cvt_pk_bf16_f32 v117, v102, v103
  s_waitcnt vmcnt(18)
  v_mfma_f32_32x32x16_bf16 v[84:99], v[136:139], v[4:7], 0
  v_exp_f32 v106, v106
  v_exp_f32 v107, v107
  v_cvt_pk_bf16_f32 v118, v104, v105
  v_exp_f32 v108, v108
  v_exp_f32 v109, v109
  v_cvt_pk_bf16_f32 v119, v106, v107
  v_exp_f32 v110, v110
  v_exp_f32 v111, v111
  v_mfma_f32_32x32x16_bf16 v[68:83], v[172:175], v[116:119], v[68:83]
  v_cvt_pk_bf16_f32 v120, v108, v109
  v_exp_f32 v112, v112
  v_exp_f32 v113, v113
  v_cvt_pk_bf16_f32 v121, v110, v111
  v_exp_f32 v114, v114
  v_exp_f32 v115, v115
  v_exp_f32 v84, v84
  v_cvt_pk_bf16_f32 v122, v112, v113
  v_exp_f32 v85, v85
  v_cvt_pk_bf16_f32 v123, v114, v115
  v_exp_f32 v86, v86
  v_exp_f32 v87, v87
  v_mfma_f32_32x32x16_bf16 v[68:83], v[176:179], v[120:123], v[68:83]
  buffer_load_dwordx4 v[132:135], v3, s[4:7], s38 offen offset:0 sc1
  s_mov_b64 exec, s[40:41]
  buffer_load_dwordx4 v[172:175], v2, s[4:7], s38 offen offset:1024 sc1
  buffer_load_dwordx4 v[176:179], v2, s[4:7], s38 offen offset:1536 sc1
  s_mov_b64 exec, -1
  v_cvt_pk_bf16_f32 v116, v84, v85
  v_exp_f32 v88, v88
  v_exp_f32 v89, v89
  v_cvt_pk_bf16_f32 v117, v86, v87
  v_mfma_f32_32x32x16_bf16 v[100:115], v[136:139], v[8:11], 0
  v_exp_f32 v90, v90
  v_exp_f32 v91, v91
  v_cvt_pk_bf16_f32 v118, v88, v89
  v_exp_f32 v92, v92
  v_exp_f32 v93, v93
  v_cvt_pk_bf16_f32 v119, v90, v91
  v_exp_f32 v94, v94
  v_exp_f32 v95, v95
  v_mfma_f32_32x32x16_bf16 v[20:35], v[180:183], v[116:119], v[20:35]
  v_cvt_pk_bf16_f32 v120, v92, v93
  v_exp_f32 v96, v96
  v_exp_f32 v97, v97
  v_cvt_pk_bf16_f32 v121, v94, v95
  v_exp_f32 v98, v98
  v_exp_f32 v99, v99
  v_exp_f32 v100, v100
  v_cvt_pk_bf16_f32 v122, v96, v97
  v_exp_f32 v101, v101
  v_cvt_pk_bf16_f32 v123, v98, v99
  v_exp_f32 v102, v102
  v_exp_f32 v103, v103
  v_mfma_f32_32x32x16_bf16 v[20:35], v[184:187], v[120:123], v[20:35]
  v_cvt_pk_bf16_f32 v116, v100, v101
  v_exp_f32 v104, v104
  v_exp_f32 v105, v105
  v_cvt_pk_bf16_f32 v117, v102, v103
  v_mfma_f32_32x32x16_bf16 v[84:99], v[136:139], v[12:15], 0
  v_exp_f32 v106, v106
  v_exp_f32 v107, v107
  v_cvt_pk_bf16_f32 v118, v104, v105
  v_exp_f32 v108, v108
  v_exp_f32 v109, v109
  v_cvt_pk_bf16_f32 v119, v106, v107
  v_exp_f32 v110, v110
  v_exp_f32 v111, v111
  v_mfma_f32_32x32x16_bf16 v[36:51], v[180:183], v[116:119], v[36:51]
  v_cvt_pk_bf16_f32 v120, v108, v109
  v_exp_f32 v112, v112
  v_exp_f32 v113, v113
  v_cvt_pk_bf16_f32 v121, v110, v111
  v_exp_f32 v114, v114
  v_exp_f32 v115, v115
  v_exp_f32 v84, v84
  v_cvt_pk_bf16_f32 v122, v112, v113
  v_exp_f32 v85, v85
  v_cvt_pk_bf16_f32 v123, v114, v115
  v_exp_f32 v86, v86
  v_exp_f32 v87, v87
  v_mfma_f32_32x32x16_bf16 v[36:51], v[184:187], v[120:123], v[36:51]
  v_cvt_pk_bf16_f32 v116, v84, v85
  v_exp_f32 v88, v88
  v_exp_f32 v89, v89
  v_cvt_pk_bf16_f32 v117, v86, v87
  v_mfma_f32_32x32x16_bf16 v[100:115], v[136:139], v[16:19], 0
  v_exp_f32 v90, v90
  v_exp_f32 v91, v91
  v_cvt_pk_bf16_f32 v118, v88, v89
  v_exp_f32 v92, v92
  v_exp_f32 v93, v93
  v_cvt_pk_bf16_f32 v119, v90, v91
  v_exp_f32 v94, v94
  v_exp_f32 v95, v95
  v_mfma_f32_32x32x16_bf16 v[52:67], v[180:183], v[116:119], v[52:67]
  v_cvt_pk_bf16_f32 v120, v92, v93
  v_exp_f32 v96, v96
  v_exp_f32 v97, v97
  v_cvt_pk_bf16_f32 v121, v94, v95
  v_exp_f32 v98, v98
  v_exp_f32 v99, v99
  v_exp_f32 v100, v100
  v_cvt_pk_bf16_f32 v122, v96, v97
  v_exp_f32 v101, v101
  v_cvt_pk_bf16_f32 v123, v98, v99
  v_exp_f32 v102, v102
  v_exp_f32 v103, v103
  v_mfma_f32_32x32x16_bf16 v[52:67], v[184:187], v[120:123], v[52:67]
  v_cvt_pk_bf16_f32 v116, v100, v101
  v_exp_f32 v104, v104
  v_exp_f32 v105, v105
  v_cvt_pk_bf16_f32 v117, v102, v103
  s_waitcnt vmcnt(18)
  v_mfma_f32_32x32x16_bf16 v[84:99], v[140:143], v[4:7], 0
  v_exp_f32 v106, v106
  v_exp_f32 v107, v107
  v_cvt_pk_bf16_f32 v118, v104, v105
  v_exp_f32 v108, v108
  v_exp_f32 v109, v109
  v_cvt_pk_bf16_f32 v119, v106, v107
  v_exp_f32 v110, v110
  v_exp_f32 v111, v111
  v_mfma_f32_32x32x16_bf16 v[68:83], v[180:183], v[116:119], v[68:83]
  v_cvt_pk_bf16_f32 v120, v108, v109
  v_exp_f32 v112, v112
  v_exp_f32 v113, v113
  v_cvt_pk_bf16_f32 v121, v110, v111
  v_exp_f32 v114, v114
  v_exp_f32 v115, v115
  v_exp_f32 v84, v84
  v_cvt_pk_bf16_f32 v122, v112, v113
  v_exp_f32 v85, v85
  v_cvt_pk_bf16_f32 v123, v114, v115
  v_exp_f32 v86, v86
  v_exp_f32 v87, v87
  v_mfma_f32_32x32x16_bf16 v[68:83], v[184:187], v[120:123], v[68:83]
  buffer_load_dwordx4 v[136:139], v3, s[4:7], s38 offen offset:2048 sc1
  s_mov_b64 exec, s[40:41]
  buffer_load_dwordx4 v[180:183], v2, s[4:7], s38 offen offset:3072 sc1
  buffer_load_dwordx4 v[184:187], v2, s[4:7], s38 offen offset:3584 sc1
  s_mov_b64 exec, -1
  s_add_u32 s38, s38, 8192
  s_and_b32 s38, s38, 0x1ffff
  v_cvt_pk_bf16_f32 v116, v84, v85
  v_exp_f32 v88, v88
  v_exp_f32 v89, v89
  v_cvt_pk_bf16_f32 v117, v86, v87
  v_mfma_f32_32x32x16_bf16 v[100:115], v[140:143], v[8:11], 0
  v_exp_f32 v90, v90
  v_exp_f32 v91, v91
  v_cvt_pk_bf16_f32 v118, v88, v89
  v_exp_f32 v92, v92
  v_exp_f32 v93, v93
  v_cvt_pk_bf16_f32 v119, v90, v91
  v_exp_f32 v94, v94
  v_exp_f32 v95, v95
  v_mfma_f32_32x32x16_bf16 v[20:35], v[188:191], v[116:119], v[20:35]
  v_cvt_pk_bf16_f32 v120, v92, v93
  v_exp_f32 v96, v96
  v_exp_f32 v97, v97
  v_cvt_pk_bf16_f32 v121, v94, v95
  v_exp_f32 v98, v98
  v_exp_f32 v99, v99
  v_exp_f32 v100, v100
  v_cvt_pk_bf16_f32 v122, v96, v97
  v_exp_f32 v101, v101
  v_cvt_pk_bf16_f32 v123, v98, v99
  v_exp_f32 v102, v102
  v_exp_f32 v103, v103
  v_mfma_f32_32x32x16_bf16 v[20:35], v[192:195], v[120:123], v[20:35]
  v_cvt_pk_bf16_f32 v116, v100, v101
  v_exp_f32 v104, v104
  v_exp_f32 v105, v105
  v_cvt_pk_bf16_f32 v117, v102, v103
  v_mfma_f32_32x32x16_bf16 v[84:99], v[140:143], v[12:15], 0
  v_exp_f32 v106, v106
  v_exp_f32 v107, v107
  v_cvt_pk_bf16_f32 v118, v104, v105
  v_exp_f32 v108, v108
  v_exp_f32 v109, v109
  v_cvt_pk_bf16_f32 v119, v106, v107
  v_exp_f32 v110, v110
  v_exp_f32 v111, v111
  v_mfma_f32_32x32x16_bf16 v[36:51], v[188:191], v[116:119], v[36:51]
  v_cvt_pk_bf16_f32 v120, v108, v109
  v_exp_f32 v112, v112
  v_exp_f32 v113, v113
  v_cvt_pk_bf16_f32 v121, v110, v111
  v_exp_f32 v114, v114
  v_exp_f32 v115, v115
  v_exp_f32 v84, v84
  v_cvt_pk_bf16_f32 v122, v112, v113
  v_exp_f32 v85, v85
  v_cvt_pk_bf16_f32 v123, v114, v115
  v_exp_f32 v86, v86
  v_exp_f32 v87, v87
  v_mfma_f32_32x32x16_bf16 v[36:51], v[192:195], v[120:123], v[36:51]
  v_cvt_pk_bf16_f32 v116, v84, v85
  v_exp_f32 v88, v88
  v_exp_f32 v89, v89
  v_cvt_pk_bf16_f32 v117, v86, v87
  v_mfma_f32_32x32x16_bf16 v[100:115], v[140:143], v[16:19], 0
  v_exp_f32 v90, v90
  v_exp_f32 v91, v91
  v_cvt_pk_bf16_f32 v118, v88, v89
  v_exp_f32 v92, v92
  v_exp_f32 v93, v93
  v_cvt_pk_bf16_f32 v119, v90, v91
  v_exp_f32 v94, v94
  v_exp_f32 v95, v95
  v_mfma_f32_32x32x16_bf16 v[52:67], v[188:191], v[116:119], v[52:67]
  v_cvt_pk_bf16_f32 v120, v92, v93
  v_exp_f32 v96, v96
  v_exp_f32 v97, v97
  v_cvt_pk_bf16_f32 v121, v94, v95
  v_exp_f32 v98, v98
  v_exp_f32 v99, v99
  v_exp_f32 v100, v100
  v_cvt_pk_bf16_f32 v122, v96, v97
  v_exp_f32 v101, v101
  v_cvt_pk_bf16_f32 v123, v98, v99
  v_exp_f32 v102, v102
  v_exp_f32 v103, v103
  v_mfma_f32_32x32x16_bf16 v[52:67], v[192:195], v[120:123], v[52:67]
  v_cvt_pk_bf16_f32 v116, v100, v101
  v_exp_f32 v104, v104
  v_exp_f32 v105, v105
  v_cvt_pk_bf16_f32 v117, v102, v103
  s_waitcnt vmcnt(18)
  v_mfma_f32_32x32x16_bf16 v[84:99], v[144:147], v[4:7], 0
  v_exp_f32 v106, v106
  v_exp_f32 v107, v107
  v_cvt_pk_bf16_f32 v118, v104, v105
  v_exp_f32 v108, v108
  v_exp_f32 v109, v109
  v_cvt_pk_bf16_f32 v119, v106, v107
  v_exp_f32 v110, v110
  v_exp_f32 v111, v111
  v_mfma_f32_32x32x16_bf16 v[68:83], v[188:191], v[116:119], v[68:83]
  v_cvt_pk_bf16_f32 v120, v108, v109
  v_exp_f32 v112, v112
  v_exp_f32 v113, v113
  v_cvt_pk_bf16_f32 v121, v110, v111
  v_exp_f32 v114, v114
  v_exp_f32 v115, v115
  v_exp_f32 v84, v84
  v_cvt_pk_bf16_f32 v122, v112, v113
  v_exp_f32 v85, v85
  v_cvt_pk_bf16_f32 v123, v114, v115
  v_exp_f32 v86, v86
  v_exp_f32 v87, v87
  v_mfma_f32_32x32x16_bf16 v[68:83], v[192:195], v[120:123], v[68:83]
  buffer_load_dwordx4 v[140:143], v3, s[4:7], s38 offen offset:0 sc1
  s_mov_b64 exec, s[40:41]
  buffer_load_dwordx4 v[188:191], v2, s[4:7], s38 offen offset:1024 sc1
  buffer_load_dwordx4 v[192:195], v2, s[4:7], s38 offen offset:1536 sc1
  s_mov_b64 exec, -1
  v_cvt_pk_bf16_f32 v116, v84, v85
  v_exp_f32 v88, v88
  v_exp_f32 v89, v89
  v_cvt_pk_bf16_f32 v117, v86, v87
  v_mfma_f32_32x32x16_bf16 v[100:115], v[144:147], v[8:11], 0
  v_exp_f32 v90, v90
  v_exp_f32 v91, v91
  v_cvt_pk_bf16_f32 v118, v88, v89
  v_exp_f32 v92, v92
  v_exp_f32 v93, v93
  v_cvt_pk_bf16_f32 v119, v90, v91
  v_exp_f32 v94, v94
  v_exp_f32 v95, v95
  v_mfma_f32_32x32x16_bf16 v[20:35], v[196:199], v[116:119], v[20:35]
  v_cvt_pk_bf16_f32 v120, v92, v93
  v_exp_f32 v96, v96
  v_exp_f32 v97, v97
  v_cvt_pk_bf16_f32 v121, v94, v95
  v_exp_f32 v98, v98
  v_exp_f32 v99, v99
  v_exp_f32 v100, v100
  v_cvt_pk_bf16_f32 v122, v96, v97
  v_exp_f32 v101, v101
  v_cvt_pk_bf16_f32 v123, v98, v99
  v_exp_f32 v102, v102
  v_exp_f32 v103, v103
  v_mfma_f32_32x32x16_bf16 v[20:35], v[200:203], v[120:123], v[20:35]
  v_cvt_pk_bf16_f32 v116, v100, v101
  v_exp_f32 v104, v104
  v_exp_f32 v105, v105
  v_cvt_pk_bf16_f32 v117, v102, v103
  v_mfma_f32_32x32x16_bf16 v[84:99], v[144:147], v[12:15], 0
  v_exp_f32 v106, v106
  v_exp_f32 v107, v107
  v_cvt_pk_bf16_f32 v118, v104, v105
  v_exp_f32 v108, v108
  v_exp_f32 v109, v109
  v_cvt_pk_bf16_f32 v119, v106, v107
  v_exp_f32 v110, v110
  v_exp_f32 v111, v111
  v_mfma_f32_32x32x16_bf16 v[36:51], v[196:199], v[116:119], v[36:51]
  v_cvt_pk_bf16_f32 v120, v108, v109
  v_exp_f32 v112, v112
  v_exp_f32 v113, v113
  v_cvt_pk_bf16_f32 v121, v110, v111
  v_exp_f32 v114, v114
  v_exp_f32 v115, v115
  v_exp_f32 v84, v84
  v_cvt_pk_bf16_f32 v122, v112, v113
  v_exp_f32 v85, v85
  v_cvt_pk_bf16_f32 v123, v114, v115
  v_exp_f32 v86, v86
  v_exp_f32 v87, v87
  v_mfma_f32_32x32x16_bf16 v[36:51], v[200:203], v[120:123], v[36:51]
  v_cvt_pk_bf16_f32 v116, v84, v85
  v_exp_f32 v88, v88
  v_exp_f32 v89, v89
  v_cvt_pk_bf16_f32 v117, v86, v87
  v_mfma_f32_32x32x16_bf16 v[100:115], v[144:147], v[16:19], 0
  v_exp_f32 v90, v90
  v_exp_f32 v91, v91
  v_cvt_pk_bf16_f32 v118, v88, v89
  v_exp_f32 v92, v92
  v_exp_f32 v93, v93
  v_cvt_pk_bf16_f32 v119, v90, v91
  v_exp_f32 v94, v94
  v_exp_f32 v95, v95
  v_mfma_f32_32x32x16_bf16 v[52:67], v[196:199], v[116:119], v[52:67]
  v_cvt_pk_bf16_f32 v120, v92, v93
  v_exp_f32 v96, v96
  v_exp_f32 v97, v97
  v_cvt_pk_bf16_f32 v121, v94, v95
  v_exp_f32 v98, v98
  v_exp_f32 v99, v99
  v_exp_f32 v100, v100
  v_cvt_pk_bf16_f32 v122, v96, v97
  v_exp_f32 v101, v101
  v_cvt_pk_bf16_f32 v123, v98, v99
  v_exp_f32 v102, v102
  v_exp_f32 v103, v103
  v_mfma_f32_32x32x16_bf16 v[52:67], v[200:203], v[120:123], v[52:67]
  v_cvt_pk_bf16_f32 v116, v100, v101
  v_exp_f32 v104, v104
  v_exp_f32 v105, v105
  v_cvt_pk_bf16_f32 v117, v102, v103
  s_waitcnt vmcnt(18)
  v_mfma_f32_32x32x16_bf16 v[84:99], v[148:151], v[4:7], 0
  v_exp_f32 v106, v106
  v_exp_f32 v107, v107
  v_cvt_pk_bf16_f32 v118, v104, v105
  v_exp_f32 v108, v108
  v_exp_f32 v109, v109
  v_cvt_pk_bf16_f32 v119, v106, v107
  v_exp_f32 v110, v110
  v_exp_f32 v111, v111
  v_mfma_f32_32x32x16_bf16 v[68:83], v[196:199], v[116:119], v[68:83]
  v_cvt_pk_bf16_f32 v120, v108, v109
  v_exp_f32 v112, v112
  v_exp_f32 v113, v113
  v_cvt_pk_bf16_f32 v121, v110, v111
  v_exp_f32 v114, v114
  v_exp_f32 v115, v115
  v_exp_f32 v84, v84
  v_cvt_pk_bf16_f32 v122, v112, v113
  v_exp_f32 v85, v85
  v_cvt_pk_bf16_f32 v123, v114, v115
  v_exp_f32 v86, v86
  v_exp_f32 v87, v87
  v_mfma_f32_32x32x16_bf16 v[68:83], v[200:203], v[120:123], v[68:83]
  buffer_load_dwordx4 v[144:147], v3, s[4:7], s38 offen offset:2048 sc1
  s_mov_b64 exec, s[40:41]
  buffer_load_dwordx4 v[196:199], v2, s[4:7], s38 offen offset:3072 sc1
  buffer_load_dwordx4 v[200:203], v2, s[4:7], s38 offen offset:3584 sc1
  s_mov_b64 exec, -1
  s_add_u32 s38, s38, 8192
  s_and_b32 s38, s38, 0x1ffff
  v_cvt_pk_bf16_f32 v116, v84, v85
  v_exp_f32 v88, v88
  v_exp_f32 v89, v89
  v_cvt_pk_bf16_f32 v117, v86, v87
  v_mfma_f32_32x32x16_bf16 v[100:115], v[148:151], v[8:11], 0
  v_exp_f32 v90, v90
  v_exp_f32 v91, v91
  v_cvt_pk_bf16_f32 v118, v88, v89
  v_exp_f32 v92, v92
  v_exp_f32 v93, v93
  v_cvt_pk_bf16_f32 v119, v90, v91
  v_exp_f32 v94, v94
  v_exp_f32 v95, v95
  v_mfma_f32_32x32x16_bf16 v[20:35], v[204:207], v[116:119], v[20:35]
  v_cvt_pk_bf16_f32 v120, v92, v93
  v_exp_f32 v96, v96
  v_exp_f32 v97, v97
  v_cvt_pk_bf16_f32 v121, v94, v95
  v_exp_f32 v98, v98
  v_exp_f32 v99, v99
  v_exp_f32 v100, v100
  v_cvt_pk_bf16_f32 v122, v96, v97
  v_exp_f32 v101, v101
  v_cvt_pk_bf16_f32 v123, v98, v99
  v_exp_f32 v102, v102
  v_exp_f32 v103, v103
  v_mfma_f32_32x32x16_bf16 v[20:35], v[208:211], v[120:123], v[20:35]
  v_cvt_pk_bf16_f32 v116, v100, v101
  v_exp_f32 v104, v104
  v_exp_f32 v105, v105
  v_cvt_pk_bf16_f32 v117, v102, v103
  v_mfma_f32_32x32x16_bf16 v[84:99], v[148:151], v[12:15], 0
  v_exp_f32 v106, v106
  v_exp_f32 v107, v107
  v_cvt_pk_bf16_f32 v118, v104, v105
  v_exp_f32 v108, v108
  v_exp_f32 v109, v109
  v_cvt_pk_bf16_f32 v119, v106, v107
  v_exp_f32 v110, v110
  v_exp_f32 v111, v111
  v_mfma_f32_32x32x16_bf16 v[36:51], v[204:207], v[116:119], v[36:51]
  v_cvt_pk_bf16_f32 v120, v108, v109
  v_exp_f32 v112, v112
  v_exp_f32 v113, v113
  v_cvt_pk_bf16_f32 v121, v110, v111
  v_exp_f32 v114, v114
  v_exp_f32 v115, v115
  v_exp_f32 v84, v84
  v_cvt_pk_bf16_f32 v122, v112, v113
  v_exp_f32 v85, v85
  v_cvt_pk_bf16_f32 v123, v114, v115
  v_exp_f32 v86, v86
  v_exp_f32 v87, v87
  v_mfma_f32_32x32x16_bf16 v[36:51], v[208:211], v[120:123], v[36:51]
  v_cvt_pk_bf16_f32 v116, v84, v85
  v_exp_f32 v88, v88
  v_exp_f32 v89, v89
  v_cvt_pk_bf16_f32 v117, v86, v87
  v_mfma_f32_32x32x16_bf16 v[100:115], v[148:151], v[16:19], 0
  v_exp_f32 v90, v90
  v_exp_f32 v91, v91
  v_cvt_pk_bf16_f32 v118, v88, v89
  v_exp_f32 v92, v92
  v_exp_f32 v93, v93
  v_cvt_pk_bf16_f32 v119, v90, v91
  v_exp_f32 v94, v94
  v_exp_f32 v95, v95
  v_mfma_f32_32x32x16_bf16 v[52:67], v[204:207], v[116:119], v[52:67]
  v_cvt_pk_bf16_f32 v120, v92, v93
  v_exp_f32 v96, v96
  v_exp_f32 v97, v97
  v_cvt_pk_bf16_f32 v121, v94, v95
  v_exp_f32 v98, v98
  v_exp_f32 v99, v99
  v_exp_f32 v100, v100
  v_cvt_pk_bf16_f32 v122, v96, v97
  v_exp_f32 v101, v101
  v_cvt_pk_bf16_f32 v123, v98, v99
  v_exp_f32 v102, v102
  v_exp_f32 v103, v103
  v_mfma_f32_32x32x16_bf16 v[52:67], v[208:211], v[120:123], v[52:67]
  v_cvt_pk_bf16_f32 v116, v100, v101
  v_exp_f32 v104, v104
  v_exp_f32 v105, v105
  v_cvt_pk_bf16_f32 v117, v102, v103
  s_waitcnt vmcnt(18)
  v_mfma_f32_32x32x16_bf16 v[84:99], v[152:155], v[4:7], 0
  v_exp_f32 v106, v106
  v_exp_f32 v107, v107
  v_cvt_pk_bf16_f32 v118, v104, v105
  v_exp_f32 v108, v108
  v_exp_f32 v109, v109
  v_cvt_pk_bf16_f32 v119, v106, v107
  v_exp_f32 v110, v110
  v_exp_f32 v111, v111
  v_mfma_f32_32x32x16_bf16 v[68:83], v[204:207], v[116:119], v[68:83]
  v_cvt_pk_bf16_f32 v120, v108, v109
  v_exp_f32 v112, v112
  v_exp_f32 v113, v113
  v_cvt_pk_bf16_f32 v121, v110, v111
  v_exp_f32 v114, v114
  v_exp_f32 v115, v115
  v_exp_f32 v84, v84
  v_cvt_pk_bf16_f32 v122, v112, v113
  v_exp_f32 v85, v85
  v_cvt_pk_bf16_f32 v123, v114, v115
  v_exp_f32 v86, v86
  v_exp_f32 v87, v87
  v_mfma_f32_32x32x16_bf16 v[68:83], v[208:211], v[120:123], v[68:83]
  buffer_load_dwordx4 v[148:151], v3, s[4:7], s38 offen offset:0 sc1
  s_mov_b64 exec, s[40:41]
  buffer_load_dwordx4 v[204:207], v2, s[4:7], s38 offen offset:1024 sc1
  buffer_load_dwordx4 v[208:211], v2, s[4:7], s38 offen offset:1536 sc1
  s_mov_b64 exec, -1
  v_cvt_pk_bf16_f32 v116, v84, v85
  v_exp_f32 v88, v88
  v_exp_f32 v89, v89
  v_cvt_pk_bf16_f32 v117, v86, v87
  v_mfma_f32_32x32x16_bf16 v[100:115], v[152:155], v[8:11], 0
  v_exp_f32 v90, v90
  v_exp_f32 v91, v91
  v_cvt_pk_bf16_f32 v118, v88, v89
  v_exp_f32 v92, v92
  v_exp_f32 v93, v93
  v_cvt_pk_bf16_f32 v119, v90, v91
  v_exp_f32 v94, v94
  v_exp_f32 v95, v95
  v_mfma_f32_32x32x16_bf16 v[20:35], v[212:215], v[116:119], v[20:35]
  v_cvt_pk_bf16_f32 v120, v92, v93
  v_exp_f32 v96, v96
  v_exp_f32 v97, v97
  v_cvt_pk_bf16_f32 v121, v94, v95
  v_exp_f32 v98, v98
  v_exp_f32 v99, v99
  v_exp_f32 v100, v100
  v_cvt_pk_bf16_f32 v122, v96, v97
  v_exp_f32 v101, v101
  v_cvt_pk_bf16_f32 v123, v98, v99
  v_exp_f32 v102, v102
  v_exp_f32 v103, v103
  v_mfma_f32_32x32x16_bf16 v[20:35], v[216:219], v[120:123], v[20:35]
  v_cvt_pk_bf16_f32 v116, v100, v101
  v_exp_f32 v104, v104
  v_exp_f32 v105, v105
  v_cvt_pk_bf16_f32 v117, v102, v103
  v_mfma_f32_32x32x16_bf16 v[84:99], v[152:155], v[12:15], 0
  v_exp_f32 v106, v106
  v_exp_f32 v107, v107
  v_cvt_pk_bf16_f32 v118, v104, v105
  v_exp_f32 v108, v108
  v_exp_f32 v109, v109
  v_cvt_pk_bf16_f32 v119, v106, v107
  v_exp_f32 v110, v110
  v_exp_f32 v111, v111
  v_mfma_f32_32x32x16_bf16 v[36:51], v[212:215], v[116:119], v[36:51]
  v_cvt_pk_bf16_f32 v120, v108, v109
  v_exp_f32 v112, v112
  v_exp_f32 v113, v113
  v_cvt_pk_bf16_f32 v121, v110, v111
  v_exp_f32 v114, v114
  v_exp_f32 v115, v115
  v_exp_f32 v84, v84
  v_cvt_pk_bf16_f32 v122, v112, v113
  v_exp_f32 v85, v85
  v_cvt_pk_bf16_f32 v123, v114, v115
  v_exp_f32 v86, v86
  v_exp_f32 v87, v87
  v_mfma_f32_32x32x16_bf16 v[36:51], v[216:219], v[120:123], v[36:51]
  v_cvt_pk_bf16_f32 v116, v84, v85
  v_exp_f32 v88, v88
  v_exp_f32 v89, v89
  v_cvt_pk_bf16_f32 v117, v86, v87
  v_mfma_f32_32x32x16_bf16 v[100:115], v[152:155], v[16:19], 0
  v_exp_f32 v90, v90
  v_exp_f32 v91, v91
  v_cvt_pk_bf16_f32 v118, v88, v89
  v_exp_f32 v92, v92
  v_exp_f32 v93, v93
  v_cvt_pk_bf16_f32 v119, v90, v91
  v_exp_f32 v94, v94
  v_exp_f32 v95, v95
  v_mfma_f32_32x32x16_bf16 v[52:67], v[212:215], v[116:119], v[52:67]
  v_cvt_pk_bf16_f32 v120, v92, v93
  v_exp_f32 v96, v96
  v_exp_f32 v97, v97
  v_cvt_pk_bf16_f32 v121, v94, v95
  v_exp_f32 v98, v98
  v_exp_f32 v99, v99
  v_exp_f32 v100, v100
  v_cvt_pk_bf16_f32 v122, v96, v97
  v_exp_f32 v101, v101
  v_cvt_pk_bf16_f32 v123, v98, v99
  v_exp_f32 v102, v102
  v_exp_f32 v103, v103
  v_mfma_f32_32x32x16_bf16 v[52:67], v[216:219], v[120:123], v[52:67]
  v_cvt_pk_bf16_f32 v116, v100, v101
  v_exp_f32 v104, v104
  v_exp_f32 v105, v105
  v_cvt_pk_bf16_f32 v117, v102, v103
  s_waitcnt vmcnt(18)
  v_mfma_f32_32x32x16_bf16 v[84:99], v[124:127], v[4:7], 0
  v_exp_f32 v106, v106
  v_exp_f32 v107, v107
  v_cvt_pk_bf16_f32 v118, v104, v105
  v_exp_f32 v108, v108
  v_exp_f32 v109, v109
  v_cvt_pk_bf16_f32 v119, v106, v107
  v_exp_f32 v110, v110
  v_exp_f32 v111, v111
  v_mfma_f32_32x32x16_bf16 v[68:83], v[212:215], v[116:119], v[68:83]
  v_cvt_pk_bf16_f32 v120, v108, v109
  v_exp_f32 v112, v112
  v_exp_f32 v113, v113
  v_cvt_pk_bf16_f32 v121, v110, v111
  v_exp_f32 v114, v114
  v_exp_f32 v115, v115
  v_exp_f32 v84, v84
  v_cvt_pk_bf16_f32 v122, v112, v113
  v_exp_f32 v85, v85
  v_cvt_pk_bf16_f32 v123, v114, v115
  v_exp_f32 v86, v86
  v_exp_f32 v87, v87
  s_sub_u32 s27, s27, 1
  s_cbranch_scc0 L_at_loop_f
  v_mfma_f32_32x32x16_bf16 v[68:83], v[216:219], v[120:123], v[68:83]
  s_waitcnt vmcnt(0)
  s_nop 15
  s_mul_i32 s46, s30, 6144
  s_add_u32 s46, s46, 81920
  v_add_u32 v220, s46, v1
  ds_write_b128 v220, v[52:55] offset:0
  ds_write_b128 v220, v[56:59] offset:1024
  ds_write_b128 v220, v[60:63] offset:2048
  ds_write_b128 v220, v[68:71] offset:3072
  ds_write_b128 v220, v[72:75] offset:4096
  ds_write_b128 v220, v[76:79] offset:5120
  s_xor_b32 s46, s30, 1
  s_mul_i32 s46, s46, 6144
  s_add_u32 s46, s46, 81920
  v_add_u32 v221, s46, v1
  s_waitcnt lgkmcnt(0)
  s_barrier
  ds_read_b128 v[52:55], v221 offset:0
  ds_read_b128 v[56:59], v221 offset:1024
  ds_read_b128 v[60:63], v221 offset:2048
  ds_read_b128 v[68:71], v221 offset:3072
  ds_read_b128 v[72:75], v221 offset:4096
  ds_read_b128 v[76:79], v221 offset:5120
  s_waitcnt lgkmcnt(3)
  v_add_f32 v20, v20, v52
  v_add_f32 v21, v21, v53
  v_add_f32 v22, v22, v54
  v_add_f32 v23, v23, v55
  v_add_f32 v24, v24, v56
  v_add_f32 v25, v25, v57
  v_add_f32 v26, v26, v58
  v_add_f32 v27, v27, v59
  v_add_f32 v28, v28, v60
  s_waitcnt lgkmcnt(0)
  v_add_f32 v36, v36, v68
  v_add_f32 v37, v37, v69
  v_add_f32 v38, v38, v70
  v_add_f32 v39, v39, v71
  v_add_f32 v40, v40, v72
  v_add_f32 v41, v41, v73
  v_add_f32 v42, v42, v74
  v_add_f32 v43, v43, v75
  v_add_f32 v44, v44, v76
  v_max3_f32 v220, |v20|, |v21|, |v22|
  v_max3_f32 v220, v220, |v23|, |v24|
  v_max3_f32 v220, v220, |v25|, |v26|
  v_max_f32 v220, v220, |v27|
  s_mov_b32 s46, 0x7f000000
  s_mov_b32 s47, 0x21800000
  s_mov_b32 s48, 0x5d800000
  v_cmp_gt_f32 s[50:51], s46, v220
  v_cmp_le_f32 s[52:53], s47, v28
  v_cmp_ge_f32 vcc, s48, v28
  s_and_b64 s[50:51], s[50:51], s[52:53]
  s_and_b64 s[50:51], s[50:51], vcc
  s_cmp_eq_u64 s[50:51], exec
  s_cbranch_scc1 L_at_ok_f_0
  v_mov_b32 v128, v4
  v_mov_b32 v129, v5
  v_mov_b32 v130, v6
  v_mov_b32 v131, v7
  v_mov_b32 v232, 0xff800000
  v_mov_b32 v20, 0
  v_mov_b32 v21, 0
  v_mov_b32 v22, 0
  v_mov_b32 v23, 0
  v_mov_b32 v24, 0
  v_mov_b32 v25, 0
  v_mov_b32 v26, 0
  v_mov_b32 v27, 0
  v_mov_b32 v28, 0
  v_mov_b32 v29, 0
  v_mov_b32 v30, 0
  v_mov_b32 v31, 0
  v_mov_b32 v32, 0
  v_mov_b32 v33, 0
  v_mov_b32 v34, 0
  v_mov_b32 v35, 0
  s_lshl_b32 s49, s33, 12
  v_subrev_u32 v224, s49, v3
  v_subrev_u32 v225, s49, v2
  s_mov_b32 s49, 0
  s_mov_b32 s54, 0
L_at_slow_f_0:
  buffer_load_dwordx4 v[124:127], v224, s[4:7], s49 offen offset:0 sc1
  s_mov_b64 exec, s[40:41]
  buffer_load_dwordx4 v[156:159], v225, s[4:7], s49 offen offset:1024 sc1
  buffer_load_dwordx4 v[160:163], v225, s[4:7], s49 offen offset:1536 sc1
  s_mov_b64 exec, -1
  s_waitcnt vmcnt(0)
  v_mfma_f32_32x32x16_bf16 v[84:99], v[124:127], v[128:131], 0
  s_nop 15
  s_nop 3
  v_max3_f32 v220, v84, v85, v86
  v_max3_f32 v220, v220, v87, v88
  v_max3_f32 v220, v220, v89, v90
  v_max3_f32 v220, v220, v91, v92
  v_max3_f32 v220, v220, v93, v94
  v_max3_f32 v220, v220, v95, v96
  v_max3_f32 v220, v220, v97, v98
  v_max_f32 v220, v220, v99
  v_mov_b32 v221, v220
  s_nop 1
  v_permlane32_swap_b32 v220, v221
  s_nop 1
  v_max3_f32 v220, v220, v221, v232
  v_sub_f32 v221, v232, v220
  v_exp_f32 v221, v221
  v_mov_b32 v232, v220
  v_sub_f32 v84, v84, v220
  v_sub_f32 v85, v85, v220
  v_sub_f32 v86, v86, v220
  v_sub_f32 v87, v87, v220
  v_sub_f32 v88, v88, v220
  v_sub_f32 v89, v89, v220
  v_sub_f32 v90, v90, v220
  v_sub_f32 v91, v91, v220
  v_sub_f32 v92, v92, v220
  v_sub_f32 v93, v93, v220
  v_sub_f32 v94, v94, v220
  v_sub_f32 v95, v95, v220
  v_sub_f32 v96, v96, v220
  v_sub_f32 v97, v97, v220
  v_sub_f32 v98, v98, v220
  v_sub_f32 v99, v99, v220
  v_exp_f32 v84, v84
  v_exp_f32 v85, v85
  v_exp_f32 v86, v86
  v_exp_f32 v87, v87
  v_exp_f32 v88, v88
  v_exp_f32 v89, v89
  v_exp_f32 v90, v90
  v_exp_f32 v91, v91
  v_exp_f32 v92, v92
  v_exp_f32 v93, v93
  v_exp_f32 v94, v94
  v_exp_f32 v95, v95
  v_exp_f32 v96, v96
  v_exp_f32 v97, v97
  v_exp_f32 v98, v98
  v_exp_f32 v99, v99
  v_mul_f32 v20, v20, v221
  v_mul_f32 v21, v21, v221
  v_mul_f32 v22, v22, v221
  v_mul_f32 v23, v23, v221
  v_mul_f32 v24, v24, v221
  v_mul_f32 v25, v25, v221
  v_mul_f32 v26, v26, v221
  v_mul_f32 v27, v27, v221
  v_mul_f32 v28, v28, v221
  v_mul_f32 v29, v29, v221
  v_mul_f32 v30, v30, v221
  v_mul_f32 v31, v31, v221
  v_mul_f32 v32, v32, v221
  v_mul_f32 v33, v33, v221
  v_mul_f32 v34, v34, v221
  v_mul_f32 v35, v35, v221
  v_cvt_pk_bf16_f32 v116, v84, v85
  v_cvt_pk_bf16_f32 v117, v86, v87
  v_cvt_pk_bf16_f32 v118, v88, v89
  v_cvt_pk_bf16_f32 v119, v90, v91
  v_cvt_pk_bf16_f32 v120, v92, v93
  v_cvt_pk_bf16_f32 v121, v94, v95
  v_cvt_pk_bf16_f32 v122, v96, v97
  v_cvt_pk_bf16_f32 v123, v98, v99
  s_nop 1
  v_mfma_f32_32x32x16_bf16 v[20:35], v[156:159], v[116:119], v[20:35]
  v_mfma_f32_32x32x16_bf16 v[20:35], v[160:163], v[120:123], v[20:35]
  s_add_u32 s49, s49, 2048
  s_nop 15
  s_nop 3
  s_add_u32 s54, s54, 1
  s_cmp_lt_u32 s54, 64
  s_cbranch_scc1 L_at_slow_f_0
L_at_ok_f_0:
  v_rcp_f32 v220, v28
  s_nop 0
  v_mul_f32 v20, v20, v220
  v_mul_f32 v21, v21, v220
  v_mul_f32 v22, v22, v220
  v_mul_f32 v23, v23, v220
  v_mul_f32 v24, v24, v220
  v_mul_f32 v25, v25, v220
  v_mul_f32 v26, v26, v220
  v_mul_f32 v27, v27, v220
  v_cvt_pk_bf16_f32 v100, v20, v21
  v_cvt_pk_bf16_f32 v101, v22, v23
  v_cvt_pk_bf16_f32 v102, v24, v25
  v_cvt_pk_bf16_f32 v103, v26, v27
  v_max3_f32 v220, |v36|, |v37|, |v38|
  v_max3_f32 v220, v220, |v39|, |v40|
  v_max3_f32 v220, v220, |v41|, |v42|
  v_max_f32 v220, v220, |v43|
  s_mov_b32 s46, 0x7f000000
  s_mov_b32 s47, 0x21800000
  s_mov_b32 s48, 0x5d800000
  v_cmp_gt_f32 s[50:51], s46, v220
  v_cmp_le_f32 s[52:53], s47, v44
  v_cmp_ge_f32 vcc, s48, v44
  s_and_b64 s[50:51], s[50:51], s[52:53]
  s_and_b64 s[50:51], s[50:51], vcc
  s_cmp_eq_u64 s[50:51], exec
  s_cbranch_scc1 L_at_ok_f_1
  v_mov_b32 v128, v8
  v_mov_b32 v129, v9
  v_mov_b32 v130, v10
  v_mov_b32 v131, v11
  v_mov_b32 v232, 0xff800000
  v_mov_b32 v36, 0
  v_mov_b32 v37, 0
  v_mov_b32 v38, 0
  v_mov_b32 v39, 0
  v_mov_b32 v40, 0
  v_mov_b32 v41, 0
  v_mov_b32 v42, 0
  v_mov_b32 v43, 0
  v_mov_b32 v44, 0
  v_mov_b32 v45, 0
  v_mov_b32 v46, 0
  v_mov_b32 v47, 0
  v_mov_b32 v48, 0
  v_mov_b32 v49, 0
  v_mov_b32 v50, 0
  v_mov_b32 v51, 0
  s_lshl_b32 s49, s33, 12
  v_subrev_u32 v224, s49, v3
  v_subrev_u32 v225, s49, v2
  s_mov_b32 s49, 0
  s_mov_b32 s54, 0
L_at_slow_f_1:
  buffer_load_dwordx4 v[124:127], v224, s[4:7], s49 offen offset:0 sc1
  s_mov_b64 exec, s[40:41]
  buffer_load_dwordx4 v[156:159], v225, s[4:7], s49 offen offset:1024 sc1
  buffer_load_dwordx4 v[160:163], v225, s[4:7], s49 offen offset:1536 sc1
  s_mov_b64 exec, -1
  s_waitcnt vmcnt(0)
  v_mfma_f32_32x32x16_bf16 v[84:99], v[124:127], v[128:131], 0
  s_nop 15
  s_nop 3
  v_max3_f32 v220, v84, v85, v86
  v_max3_f32 v220, v220, v87, v88
  v_max3_f32 v220, v220, v89, v90
  v_max3_f32 v220, v220, v91, v92
  v_max3_f32 v220, v220, v93, v94
  v_max3_f32 v220, v220, v95, v96
  v_max3_f32 v220, v220, v97, v98
  v_max_f32 v220, v220, v99
  v_mov_b32 v221, v220
  s_nop 1
  v_permlane32_swap_b32 v220, v221
  s_nop 1
  v_max3_f32 v220, v220, v221, v232
  v_sub_f32 v221, v232, v220
  v_exp_f32 v221, v221
  v_mov_b32 v232, v220
  v_sub_f32 v84, v84, v220
  v_sub_f32 v85, v85, v220
  v_sub_f32 v86, v86, v220
  v_sub_f32 v87, v87, v220
  v_sub_f32 v88, v88, v220
  v_sub_f32 v89, v89, v220
  v_sub_f32 v90, v90, v220
  v_sub_f32 v91, v91, v220
  v_sub_f32 v92, v92, v220
  v_sub_f32 v93, v93, v220
  v_sub_f32 v94, v94, v220
  v_sub_f32 v95, v95, v220
  v_sub_f32 v96, v96, v220
  v_sub_f32 v97, v97, v220
  v_sub_f32 v98, v98, v220
  v_sub_f32 v99, v99, v220
  v_exp_f32 v84, v84
  v_exp_f32 v85, v85
  v_exp_f32 v86, v86
  v_exp_f32 v87, v87
  v_exp_f32 v88, v88
  v_exp_f32 v89, v89
  v_exp_f32 v90, v90
  v_exp_f32 v91, v91
  v_exp_f32 v92, v92
  v_exp_f32 v93, v93
  v_exp_f32 v94, v94
  v_exp_f32 v95, v95
  v_exp_f32 v96, v96
  v_exp_f32 v97, v97
  v_exp_f32 v98, v98
  v_exp_f32 v99, v99
  v_mul_f32 v36, v36, v221
  v_mul_f32 v37, v37, v221
  v_mul_f32 v38, v38, v221
  v_mul_f32 v39, v39, v221
  v_mul_f32 v40, v40, v221
  v_mul_f32 v41, v41, v221
  v_mul_f32 v42, v42, v221
  v_mul_f32 v43, v43, v221
  v_mul_f32 v44, v44, v221
  v_mul_f32 v45, v45, v221
  v_mul_f32 v46, v46, v221
  v_mul_f32 v47, v47, v221
  v_mul_f32 v48, v48, v221
  v_mul_f32 v49, v49, v221
  v_mul_f32 v50, v50, v221
  v_mul_f32 v51, v51, v221
  v_cvt_pk_bf16_f32 v116, v84, v85
  v_cvt_pk_bf16_f32 v117, v86, v87
  v_cvt_pk_bf16_f32 v118, v88, v89
  v_cvt_pk_bf16_f32 v119, v90, v91
  v_cvt_pk_bf16_f32 v120, v92, v93
  v_cvt_pk_bf16_f32 v121, v94, v95
  v_cvt_pk_bf16_f32 v122, v96, v97
  v_cvt_pk_bf16_f32 v123, v98, v99
  s_nop 1
  v_mfma_f32_32x32x16_bf16 v[36:51], v[156:159], v[116:119], v[36:51]
  v_mfma_f32_32x32x16_bf16 v[36:51], v[160:163], v[120:123], v[36:51]
  s_add_u32 s49, s49, 2048
  s_nop 15
  s_nop 3
  s_add_u32 s54, s54, 1
  s_cmp_lt_u32 s54, 64
  s_cbranch_scc1 L_at_slow_f_1
L_at_ok_f_1:
  v_rcp_f32 v220, v44
  s_nop 0
  v_mul_f32 v36, v36, v220
  v_mul_f32 v37, v37, v220
  v_mul_f32 v38, v38, v220
  v_mul_f32 v39, v39, v220
  v_mul_f32 v40, v40, v220
  v_mul_f32 v41, v41, v220
  v_mul_f32 v42, v42, v220
  v_mul_f32 v43, v43, v220
  v_cvt_pk_bf16_f32 v104, v36, v37
  v_cvt_pk_bf16_f32 v105, v38, v39
  v_cvt_pk_bf16_f32 v106, v40, v41
  v_cvt_pk_bf16_f32 v107, v42, v43
  s_lshl_b32 s96, s29, 1
  s_add_u32 s96, s96, s33
  s_lshl_b32 s96, s96, 6
  s_add_u32 s96, s96, s32
  s_lshl_b32 s96, s96, 10
  s_add_u32 s96, s96, 6291456
  buffer_store_dwordx4 v[100:103], v1, s[4:7], s96 offen sc1
  s_add_u32 s96, s96, 32768
  buffer_store_dwordx4 v[104:107], v1, s[4:7], s96 offen sc1
  s_and_b32 s56, s2, 7
  s_lshl_b32 s56, s56, 2
  s_lshr_b32 s36, s2, 6
  s_add_u32 s56, s56, s36
  s_bfe_u32 s57, s2, 0x30003
  s_lshr_b32 s58, s56, 1
  s_and_b32 s36, s31, 1
  s_lshl_b32 s42, s56, 1
  s_add_u32 s42, s42, s36
  s_lshr_b32 s36, s31, 1
  s_lshl_b32 s43, s57, 1
  s_add_u32 s43, s43, s36
  s_lshr_b32 s36, s31, 1
  s_lshl_b32 s36, s36, 14
  s_add_u32 s36, s36, 0
  v_add_u32 v174, s36, v1
  ds_read_b128 v[40:43], v174 offset:0
  ds_read_b128 v[44:47], v174 offset:1024
  ds_read_b128 v[48:51], v174 offset:2048
  ds_read_b128 v[52:55], v174 offset:3072
  ds_read_b128 v[56:59], v174 offset:4096
  ds_read_b128 v[60:63], v174 offset:5120
  ds_read_b128 v[64:67], v174 offset:6144
  ds_read_b128 v[68:71], v174 offset:7168
  ds_read_b128 v[72:75], v174 offset:8192
  ds_read_b128 v[76:79], v174 offset:9216
  ds_read_b128 v[80:83], v174 offset:10240
  ds_read_b128 v[84:87], v174 offset:11264
  ds_read_b128 v[88:91], v174 offset:12288
  ds_read_b128 v[92:95], v174 offset:13312
  ds_read_b128 v[96:99], v174 offset:14336
  s_waitcnt lgkmcnt(7)
  ds_read_b128 v[100:103], v174 offset:15360
  v_lshlrev_b32 v168, 7, v0
  s_lshl_b32 s44, s42, 5
  s_add_u32 s44, s44, 0
  s_lshl_b32 s44, s44, 10
  s_add_u32 s44, s44, 6291456
  s_mov_b32 s26, 400000
  v_lshlrev_b32 v168, 10, v0
  v_add_u32 v168, 896, v168
L_osent_m:
  s_mov_b32 exec_lo, 0xffff
  s_mov_b32 exec_hi, 0
  buffer_load_dword v170, v168, s[4:7], s44 offen sc1
  s_waitcnt vmcnt(0)
  v_cmp_eq_u32 vcc, -1, v170
  s_mov_b64 exec, -1
  s_cbranch_vccz L_osent_go_m
  s_sub_u32 s26, s26, 1
  s_cbranch_scc1 L_osent_go_m
  s_sleep 1
  s_branch L_osent_m
L_osent_go_m:
  s_mov_b32 s97, s44
  buffer_load_dwordx4 v[104:107], v1, s[4:7], s97 offen offset:0 sc1
  buffer_load_dwordx4 v[108:111], v1, s[4:7], s97 offen offset:1024 sc1
  buffer_load_dwordx4 v[112:115], v1, s[4:7], s97 offen offset:2048 sc1
  buffer_load_dwordx4 v[116:119], v1, s[4:7], s97 offen offset:3072 sc1
  s_add_u32 s97, s97, 4096
  buffer_load_dwordx4 v[120:123], v1, s[4:7], s97 offen offset:0 sc1
  buffer_load_dwordx4 v[124:127], v1, s[4:7], s97 offen offset:1024 sc1
  buffer_load_dwordx4 v[128:131], v1, s[4:7], s97 offen offset:2048 sc1
  buffer_load_dwordx4 v[132:135], v1, s[4:7], s97 offen offset:3072 sc1
  s_add_u32 s97, s97, 4096
  buffer_load_dwordx4 v[136:139], v1, s[4:7], s97 offen offset:0 sc1
  buffer_load_dwordx4 v[140:143], v1, s[4:7], s97 offen offset:1024 sc1
  buffer_load_dwordx4 v[144:147], v1, s[4:7], s97 offen offset:2048 sc1
  buffer_load_dwordx4 v[148:151], v1, s[4:7], s97 offen offset:3072 sc1
  s_add_u32 s97, s97, 4096
  buffer_load_dwordx4 v[152:155], v1, s[4:7], s97 offen offset:0 sc1
  buffer_load_dwordx4 v[156:159], v1, s[4:7], s97 offen offset:1024 sc1
  buffer_load_dwordx4 v[160:163], v1, s[4:7], s97 offen offset:2048 sc1
  buffer_load_dwordx4 v[164:167], v1, s[4:7], s97 offen offset:3072 sc1
  v_mov_b32 v170, 0
  s_waitcnt vmcnt(15) lgkmcnt(0)
  v_mfma_f32_32x32x16_bf16 v[24:39], v[104:107], v[40:43], 0
  v_max3_u32 v170, v170, v104, v105
  v_max3_u32 v170, v170, v106, v107
  s_waitcnt vmcnt(14)
  v_mfma_f32_32x32x16_bf16 v[24:39], v[108:111], v[44:47], v[24:39]
  v_max3_u32 v170, v170, v108, v109
  v_max3_u32 v170, v170, v110, v111
  s_waitcnt vmcnt(13)
  v_mfma_f32_32x32x16_bf16 v[24:39], v[112:115], v[48:51], v[24:39]
  v_max3_u32 v170, v170, v112, v113
  v_max3_u32 v170, v170, v114, v115
  s_waitcnt vmcnt(12)
  v_mfma_f32_32x32x16_bf16 v[24:39], v[116:119], v[52:55], v[24:39]
  v_max3_u32 v170, v170, v116, v117
  v_max3_u32 v170, v170, v118, v119
  s_waitcnt vmcnt(11)
  v_mfma_f32_32x32x16_bf16 v[24:39], v[120:123], v[56:59], v[24:39]
  v_max3_u32 v170, v170, v120, v121
  v_max3_u32 v170, v170, v122, v123
  s_waitcnt vmcnt(10)
  v_mfma_f32_32x32x16_bf16 v[24:39], v[124:127], v[60:63], v[24:39]
  v_max3_u32 v170, v170, v124, v125
  v_max3_u32 v170, v170, v126, v127
  s_waitcnt vmcnt(9)
  v_mfma_f32_32x32x16_bf16 v[24:39], v[128:131], v[64:67], v[24:39]
  v_max3_u32 v170, v170, v128, v129
  v_max3_u32 v170, v170, v130, v131
  s_waitcnt vmcnt(8)
  v_mfma_f32_32x32x16_bf16 v[24:39], v[132:135], v[68:71], v[24:39]
  v_max3_u32 v170, v170, v132, v133
  v_max3_u32 v170, v170, v134, v135
  s_waitcnt vmcnt(7)
  v_mfma_f32_32x32x16_bf16 v[24:39], v[136:139], v[72:75], v[24:39]
  v_max3_u32 v170, v170, v136, v137
  v_max3_u32 v170, v170, v138, v139
  s_waitcnt vmcnt(6)
  v_mfma_f32_32x32x16_bf16 v[24:39], v[140:143], v[76:79], v[24:39]
  v_max3_u32 v170, v170, v140, v141
  v_max3_u32 v170, v170, v142, v143
  s_waitcnt vmcnt(5)
  v_mfma_f32_32x32x16_bf16 v[24:39], v[144:147], v[80:83], v[24:39]
  v_max3_u32 v170, v170, v144, v145
  v_max3_u32 v170, v170, v146, v147
  s_waitcnt vmcnt(4)
  v_mfma_f32_32x32x16_bf16 v[24:39], v[148:151], v[84:87], v[24:39]
  v_max3_u32 v170, v170, v148, v149
  v_max3_u32 v170, v170, v150, v151
  s_waitcnt vmcnt(3)
  v_mfma_f32_32x32x16_bf16 v[24:39], v[152:155], v[88:91], v[24:39]
  v_max3_u32 v170, v170, v152, v153
  v_max3_u32 v170, v170, v154, v155
  s_waitcnt vmcnt(2)
  v_mfma_f32_32x32x16_bf16 v[24:39], v[156:159], v[92:95], v[24:39]
  v_max3_u32 v170, v170, v156, v157
  v_max3_u32 v170, v170, v158, v159
  s_waitcnt vmcnt(1)
  v_mfma_f32_32x32x16_bf16 v[24:39], v[160:163], v[96:99], v[24:39]
  v_max3_u32 v170, v170, v160, v161
  v_max3_u32 v170, v170, v162, v163
  s_waitcnt vmcnt(0)
  v_mfma_f32_32x32x16_bf16 v[24:39], v[164:167], v[100:103], v[24:39]
  v_max3_u32 v170, v170, v164, v165
  v_max3_u32 v170, v170, v166, v167
  v_cmp_eq_u32 vcc, -1, v170
  s_cbranch_vccz L_osent_ok_m
  s_nop 15
  s_sub_u32 s26, s26, 1
  s_cbranch_scc0 L_osent_m
L_osent_ok_m:
  s_nop 15
  s_lshl_b32 s36, s31, 12
  s_add_u32 s36, s36, 106496
  v_add_u32 v168, s36, v1
  ds_write_b128 v168, v[24:27] offset:0
  ds_write_b128 v168, v[28:31] offset:1024
  ds_write_b128 v168, v[32:35] offset:2048
  ds_write_b128 v168, v[36:39] offset:3072
  s_waitcnt lgkmcnt(0)
  s_barrier
  s_add_u32 s36, s2, s30
  s_cmp_lg_u32 s36, 0
  s_cbranch_scc1 L_f_nononce
  s_mov_b64 exec, 1
  v_mov_b32 v168, s24
  v_mov_b32 v169, 0
  s_mov_b32 s36, 23265280
  buffer_store_dword v168, v169, s[4:7], s36 offen sc1
L_f_nononce:
  s_branch L_f_end
L_f_helper:
  v_lshrrev_b32 v172, 4, v0
  v_and_b32 v173, 7, v0
  v_xor_b32 v172, v172, v173
  v_lshlrev_b32 v172, 4, v172
  v_lshrrev_b32 v173, 5, v0
  v_lshlrev_b32 v173, 4, v173
  v_bfe_u32 v174, v0, 3, 2
  v_add_u32 v173, v173, v174
  v_lshl_add_u32 v2, v173, 10, v172
  v_xor_b32 v3, 64, v2
  s_lshl_b32 s32, s29, 2
  s_add_u32 s32, s32, s31
  s_lshl_b32 s32, s32, 15
  s_lshl_b32 s35, s31, 12
  v_add_u32 v173, 0, v1
  v_mul_u32_u24 v174, 21846, v173
  v_lshrrev_b32 v174, 22, v174
  v_mul_u32_u24 v175, 192, v174
  v_sub_u32 v175, v173, v175
  v_lshrrev_b32 v176, 6, v175
  v_and_b32 v175, 63, v175
  v_mul_u32_u24 v174, 3072, v174
  v_lshl_add_u32 v174, v176, 10, v174
  v_add_u32 v4, v174, v175
  v_add_u32 v173, 1024, v1
  v_mul_u32_u24 v174, 21846, v173
  v_lshrrev_b32 v174, 22, v174
  v_mul_u32_u24 v175, 192, v174
  v_sub_u32 v175, v173, v175
  v_lshrrev_b32 v176, 6, v175
  v_and_b32 v175, 63, v175
  v_mul_u32_u24 v174, 3072, v174
  v_lshl_add_u32 v174, v176, 10, v174
  v_add_u32 v5, v174, v175
  v_add_u32 v173, 2048, v1
  v_mul_u32_u24 v174, 21846, v173
  v_lshrrev_b32 v174, 22, v174
  v_mul_u32_u24 v175, 192, v174
  v_sub_u32 v175, v173, v175
  v_lshrrev_b32 v176, 6, v175
  v_and_b32 v175, 63, v175
  v_mul_u32_u24 v174, 3072, v174
  v_lshl_add_u32 v174, v176, 10, v174
  v_add_u32 v6, v174, v175
  s_mul_i32 s33, s31, 49152
  s_lshl_b32 s36, s28, 6
  s_add_u32 s33, s33, s36
  s_mul_i32 s38, s31, 3072
  s_add_u32 s38, s38, 65536
  v_lshrrev_b32 v173, 3, v0
  v_lshl_add_u32 v7, v173, 10, v172
  s_and_b32 s36, s31, 1
  s_lshl_b32 s36, s36, 6
  v_xor_b32 v7, s36, v7
  s_lshl_b32 s34, s28, 2
  s_add_u32 s34, s34, s31
  s_lshl_b32 s34, s34, 13
  s_lshl_b32 s39, s31, 10
  s_add_u32 s39, s39, 65536
  s_load_dwordx2 s[40:41], s[0:1], 32
  s_load_dwordx2 s[44:45], s[0:1], 40
  s_load_dwordx2 s[48:49], s[0:1], 80
  s_load_dwordx2 s[52:53], s[0:1], 96
  s_waitcnt lgkmcnt(0)
  s_mov_b32 s6, 0x1650000
  s_mov_b32 s7, 0x00020000
  s_mov_b32 s10, 0x200000
  s_mov_b32 s11, 0x00020000
  s_mov_b32 s14, 0x180000
  s_mov_b32 s15, 0x00020000
  s_mov_b32 s18, 0x80000
  s_mov_b32 s19, 0x00020000
  s_mov_b32 s22, 0x80000
  s_mov_b32 s23, 0x00020000
  s_mov_b32 s42, 0x400
  s_mov_b32 s43, 0x00020000
  s_mov_b32 s46, 0x400
  s_mov_b32 s47, 0x00020000
  s_mov_b32 s50, 0x400
  s_mov_b32 s51, 0x00020000
  s_mov_b32 s54, 0x400
  s_mov_b32 s55, 0x00020000
  v_mov_b32 v20, 139264
  v_mov_b32 v21, 0
  ds_write_b32 v20, v21
  s_add_u32 m0, s35, 0
  s_add_u32 s36, s32, 0
  buffer_load_dwordx4 v2, s[8:11], s36 offen lds
  s_add_u32 m0, s35, 1024
  s_add_u32 s36, s32, 4096
  buffer_load_dwordx4 v3, s[8:11], s36 offen lds
  s_add_u32 m0, s35, 2048
  s_add_u32 s36, s32, 8192
  buffer_load_dwordx4 v2, s[8:11], s36 offen lds
  s_add_u32 m0, s35, 3072
  s_add_u32 s36, s32, 12288
  buffer_load_dwordx4 v3, s[8:11], s36 offen lds
  s_add_u32 s36, s33, 0
  s_add_u32 m0, s38, 0
  s_nop 0
  buffer_load_dwordx4 v4, s[12:15], s36 offen lds
  s_add_u32 m0, s38, 1024
  s_nop 0
  buffer_load_dwordx4 v5, s[12:15], s36 offen lds
  s_add_u32 m0, s38, 2048
  s_nop 0
  buffer_load_dwordx4 v6, s[12:15], s36 offen lds
  v_mov_b32 v30, 0
  s_mov_b32 s36, 23265280
  buffer_load_dword v30, v30, s[4:7], s36 offen sc1
  s_lshl_b32 s36, s29, 4
  s_add_u32 s36, s36, s28
  s_lshl_b32 s36, s36, 2
  s_add_u32 s36, s36, s31
  s_lshl_b32 s36, s36, 11
  buffer_load_dwordx4 v[128:131], v1, s[52:55], 0 offen
  buffer_load_dwordx4 v[132:135], v1, s[8:11], s36 offen
  buffer_load_dwordx4 v[136:139], v1, s[8:11], s36 offen offset:1024
  v_lshrrev_b32 v88, 3, v0
  s_lshl_b32 s36, s28, 5
  s_lshl_b32 s37, s31, 3
  s_add_u32 s36, s36, s37
  v_add_u32 v88, s36, v88
  v_lshlrev_b32 v82, 1, v88
  v_and_b32 v89, 7, v0
  buffer_load_ushort v76, v82, s[40:43], 0 offen
  buffer_load_ushort v77, v82, s[44:47], 0 offen
  buffer_load_ushort v78, v82, s[48:51], 0 offen
  s_waitcnt lgkmcnt(0)
  s_barrier
  s_waitcnt vmcnt(7)
  s_barrier
  s_waitcnt vmcnt(0)
  v_readfirstlane_b32 s24, v30
  s_nop 3
  s_add_u32 s24, s24, 1
  s_xor_b32 s25, s24, 0x5bd1e995
  v_lshlrev_b32 v76, 16, v76
  v_lshlrev_b32 v77, 16, v77
  v_lshlrev_b32 v78, 16, v78
  v_mul_f32 v78, 0x3fb8aa3b, v78
  v_exp_f32 v78, v78
  s_nop 0
  v_cvt_pk_bf16_f32 v78, v78, v78
  v_lshlrev_b32 v78, 16, v78
  v_mul_f32 v79, v78, v76
  v_mul_f32 v80, v78, v77
  v_mul_f32 v79, 0x3fb8aa3b, v79
  v_exp_f32 v79, v79
  v_mul_f32 v80, 0.15915494, v80
  v_fract_f32 v80, v80
  v_cos_f32 v56, v80
  v_sin_f32 v57, v80
  s_nop 0
  v_mul_f32 v56, v56, v79
  v_mul_f32 v57, v57, v79
  v_add_f32 v79, -1.0, v56
  v_mul_f32 v80, v76, v76
  v_fmac_f32 v80, v77, v77
  v_rcp_f32 v80, v80
  v_mul_f32 v58, v79, v76
  v_fmac_f32 v58, v57, v77
  v_mul_f32 v59, v57, v76
  v_fma_f32 v59, -v79, v77, v59
  v_mul_f32 v58, v58, v80
  v_mul_f32 v59, v59, v80
  v_mul_f32 v76, v56, v56
  v_mul_f32 v77, v56, v57
  v_fma_f32 v76, -v57, v57, v76
  v_add_f32 v77, v77, v77
  v_mul_f32 v78, v76, v76
  v_mul_f32 v79, v76, v77
  v_fma_f32 v78, -v77, v77, v78
  v_add_f32 v79, v79, v79
  v_mul_f32 v76, v78, v78
  v_mul_f32 v77, v78, v79
  v_fma_f32 v76, -v79, v79, v76
  v_add_f32 v77, v77, v77
  v_mul_f32 v60, v76, v76
  v_mul_f32 v61, v76, v77
  v_fma_f32 v60, -v77, v77, v60
  v_add_f32 v61, v61, v61
  v_mul_f32 v62, v60, v60
  v_mul_f32 v63, v60, v61
  v_fma_f32 v62, -v61, v61, v62
  v_add_f32 v63, v63, v63
  v_mul_f32 v64, v62, v62
  v_mul_f32 v65, v62, v63
  v_fma_f32 v64, -v63, v63, v64
  v_add_f32 v65, v65, v65
  v_mul_f32 v66, v64, v64
  v_mul_f32 v67, v64, v65
  v_fma_f32 v66, -v65, v65, v66
  v_add_f32 v67, v67, v67
  v_mov_b32 v216, 0
  v_mov_b32 v217, 0
  v_dot2c_f32_bf16 v216, v132, v128
  v_dot2c_f32_bf16 v216, v133, v129
  v_dot2c_f32_bf16 v216, v134, v130
  v_dot2c_f32_bf16 v216, v135, v131
  v_dot2c_f32_bf16 v217, v136, v128
  v_dot2c_f32_bf16 v217, v137, v129
  v_dot2c_f32_bf16 v217, v138, v130
  v_dot2c_f32_bf16 v217, v139, v131
  s_nop 1
  v_add_f32_dpp v216, v216, v216 row_shr:1 row_mask:0xf bank_mask:0xf bound_ctrl:1
  v_add_f32_dpp v217, v217, v217 row_shr:1 row_mask:0xf bank_mask:0xf bound_ctrl:1
  s_nop 1
  v_add_f32_dpp v216, v216, v216 row_shr:2 row_mask:0xf bank_mask:0xf bound_ctrl:1
  v_add_f32_dpp v217, v217, v217 row_shr:2 row_mask:0xf bank_mask:0xf bound_ctrl:1
  s_nop 1
  v_add_f32_dpp v216, v216, v216 row_shr:4 row_mask:0xf bank_mask:0xf bound_ctrl:1
  v_add_f32_dpp v217, v217, v217 row_shr:4 row_mask:0xf bank_mask:0xf bound_ctrl:1
  s_nop 1
  v_add_f32_dpp v216, v216, v216 row_shr:8 row_mask:0xf bank_mask:0xf bound_ctrl:1
  v_add_f32_dpp v217, v217, v217 row_shr:8 row_mask:0xf bank_mask:0xf bound_ctrl:1
  s_nop 1
  v_add_f32_dpp v216, v216, v216 row_bcast:15 row_mask:0xa bank_mask:0xf
  v_add_f32_dpp v217, v217, v217 row_bcast:15 row_mask:0xa bank_mask:0xf
  s_nop 1
  v_add_f32_dpp v216, v216, v216 row_bcast:31 row_mask:0xc bank_mask:0xf
  v_add_f32_dpp v217, v217, v217 row_bcast:31 row_mask:0xc bank_mask:0xf
  v_mul_f32 v216, 0xbfb8aa3b, v216
  v_mul_f32 v217, 0xbfb8aa3b, v217
  v_exp_f32 v216, v216
  v_exp_f32 v217, v217
  s_nop 0
  v_add_f32 v216, 1.0, v216
  v_add_f32 v217, 1.0, v217
  v_rcp_f32 v216, v216
  v_rcp_f32 v217, v217
  v_cmp_le_u32 vcc, 1, v89
  s_nop 1
  v_cndmask_b32 v200, 0, v60, vcc
  v_cndmask_b32 v201, 0, v61, vcc
  v_cmp_le_u32 vcc, 2, v89
  s_nop 1
  v_cndmask_b32 v202, 0, v62, vcc
  v_cndmask_b32 v203, 0, v63, vcc
  v_cmp_le_u32 vcc, 4, v89
  s_nop 1
  v_cndmask_b32 v204, 0, v64, vcc
  v_cndmask_b32 v205, 0, v65, vcc
  v_cmp_eq_u32 s[46:47], 0, v89
  v_lshrrev_b32 v76, 3, v0
  s_lshl_b32 s36, s31, 3
  v_add_u32 v76, s36, v76
  v_lshl_add_u32 v77, v89, 5, v76
  v_lshlrev_b32 v77, 7, v77
  v_and_b32 v78, 3, v76
  v_xor_b32 v79, 0, v78
  v_lshl_add_u32 v206, v79, 4, v77
  v_xor_b32 v79, 1, v78
  v_lshl_add_u32 v207, v79, 4, v77
  v_xor_b32 v79, 2, v78
  v_lshl_add_u32 v208, v79, 4, v77
  v_xor_b32 v79, 3, v78
  v_lshl_add_u32 v209, v79, 4, v77
  s_mul_i32 s36, s31, 5120
  s_add_u32 s36, s36, 40960
  v_lshrrev_b32 v76, 3, v0
  v_mul_u32_u24 v76, 320, v76
  v_lshl_add_u32 v76, v89, 5, v76
  v_add_u32 v210, s36, v76
  v_lshrrev_b32 v77, 5, v0
  v_bfe_u32 v78, v0, 2, 2
  v_lshl_add_u32 v77, v77, 3, v78
  v_mul_u32_u24 v77, 320, v77
  v_and_b32 v78, 1, v0
  v_lshlrev_b32 v78, 5, v78
  v_bfe_u32 v79, v0, 4, 1
  v_lshl_add_u32 v78, v79, 4, v78
  v_bfe_u32 v79, v0, 1, 1
  v_lshl_add_u32 v78, v79, 3, v78
  v_add3_u32 v211, v77, v78, s36
  v_lshlrev_b32 v212, 3, v88
  v_mov_b32 v213, 0
  v_lshlrev_b32 v214, 7, v0
  s_load_dwordx2 s[56:57], s[0:1], 64
  s_load_dwordx2 s[60:61], s[0:1], 72
  s_load_dwordx2 s[64:65], s[0:1], 16
  s_load_dwordx2 s[68:69], s[0:1], 104
  s_load_dwordx2 s[72:73], s[0:1], 88
  s_waitcnt lgkmcnt(0)
  s_mov_b32 s58, 0x80000
  s_mov_b32 s59, 0x00020000
  s_mov_b32 s62, 0x80000
  s_mov_b32 s63, 0x00020000
  s_mov_b32 s66, 0x80000
  s_mov_b32 s67, 0x00020000
  s_mov_b32 s70, 0x400000
  s_mov_b32 s71, 0x00020000
  s_mov_b32 s74, 0x400
  s_mov_b32 s75, 0x00020000
  v_mov_b32 v144, -1
  v_mov_b32 v145, -1
  v_mov_b32 v146, -1
  v_mov_b32 v147, -1
  v_add_f32 v58, v58, v58
  v_add_f32 v59, v59, v59
  s_add_u32 m0, s35, 16384
  s_add_u32 s36, s32, 128
  buffer_load_dwordx4 v2, s[8:11], s36 offen lds
  s_add_u32 m0, s35, 17408
  s_add_u32 s36, s32, 4224
  buffer_load_dwordx4 v3, s[8:11], s36 offen lds
  s_add_u32 m0, s35, 18432
  s_add_u32 s36, s32, 8320
  buffer_load_dwordx4 v2, s[8:11], s36 offen lds
  s_add_u32 m0, s35, 19456
  s_add_u32 s36, s32, 12416
  buffer_load_dwordx4 v3, s[8:11], s36 offen lds
  s_add_u32 s36, s33, 196608
  s_add_u32 m0, s38, 12288
  s_nop 0
  buffer_load_dwordx4 v4, s[12:15], s36 offen lds
  s_add_u32 m0, s38, 13312
  s_nop 0
  buffer_load_dwordx4 v5, s[12:15], s36 offen lds
  s_add_u32 m0, s38, 14336
  s_nop 0
  buffer_load_dwordx4 v6, s[12:15], s36 offen lds
  s_add_u32 m0, s35, 32768
  s_add_u32 s36, s32, 256
  buffer_load_dwordx4 v2, s[8:11], s36 offen lds
  s_add_u32 m0, s35, 33792
  s_add_u32 s36, s32, 4352
  buffer_load_dwordx4 v3, s[8:11], s36 offen lds
  s_add_u32 m0, s35, 34816
  s_add_u32 s36, s32, 8448
  buffer_load_dwordx4 v2, s[8:11], s36 offen lds
  s_add_u32 m0, s35, 35840
  s_add_u32 s36, s32, 12544
  buffer_load_dwordx4 v3, s[8:11], s36 offen lds
  s_add_u32 s36, s33, 393216
  s_add_u32 m0, s38, 24576
  s_nop 0
  buffer_load_dwordx4 v4, s[12:15], s36 offen lds
  s_add_u32 m0, s38, 25600
  s_nop 0
  buffer_load_dwordx4 v5, s[12:15], s36 offen lds
  s_add_u32 m0, s38, 26624
  s_nop 0
  buffer_load_dwordx4 v6, s[12:15], s36 offen lds
  s_add_u32 m0, s35, 49152
  s_add_u32 s36, s32, 384
  buffer_load_dwordx4 v2, s[8:11], s36 offen lds
  s_add_u32 m0, s35, 50176
  s_add_u32 s36, s32, 4480
  buffer_load_dwordx4 v3, s[8:11], s36 offen lds
  s_add_u32 m0, s35, 51200
  s_add_u32 s36, s32, 8576
  buffer_load_dwordx4 v2, s[8:11], s36 offen lds
  s_add_u32 m0, s35, 52224
  s_add_u32 s36, s32, 12672
  buffer_load_dwordx4 v3, s[8:11], s36 offen lds
  s_add_u32 s36, s33, 589824
  s_add_u32 m0, s38, 36864
  s_nop 0
  buffer_load_dwordx4 v4, s[12:15], s36 offen lds
  s_add_u32 m0, s38, 37888
  s_nop 0
  buffer_load_dwordx4 v5, s[12:15], s36 offen lds
  s_add_u32 m0, s38, 38912
  s_nop 0
  buffer_load_dwordx4 v6, s[12:15], s36 offen lds
  s_waitcnt vmcnt(14)
  s_barrier
  s_waitcnt vmcnt(7)
  s_barrier
  s_add_u32 m0, s35, 0
  s_add_u32 s36, s32, 512
  buffer_load_dwordx4 v2, s[8:11], s36 offen lds
  s_add_u32 m0, s35, 1024
  s_add_u32 s36, s32, 4608
  buffer_load_dwordx4 v3, s[8:11], s36 offen lds
  s_add_u32 m0, s35, 2048
  s_add_u32 s36, s32, 8704
  buffer_load_dwordx4 v2, s[8:11], s36 offen lds
  s_add_u32 m0, s35, 3072
  s_add_u32 s36, s32, 12800
  buffer_load_dwordx4 v3, s[8:11], s36 offen lds
  s_add_u32 s36, s33, 786432
  s_add_u32 m0, s38, 0
  s_nop 0
  buffer_load_dwordx4 v4, s[12:15], s36 offen lds
  s_add_u32 m0, s38, 1024
  s_nop 0
  buffer_load_dwordx4 v5, s[12:15], s36 offen lds
  s_add_u32 m0, s38, 2048
  s_nop 0
  buffer_load_dwordx4 v6, s[12:15], s36 offen lds
  s_waitcnt vmcnt(7)
  s_barrier
  s_add_u32 m0, s35, 16384
  s_add_u32 s36, s32, 640
  buffer_load_dwordx4 v2, s[8:11], s36 offen lds
  s_add_u32 m0, s35, 17408
  s_add_u32 s36, s32, 4736
  buffer_load_dwordx4 v3, s[8:11], s36 offen lds
  s_add_u32 m0, s35, 18432
  s_add_u32 s36, s32, 8832
  buffer_load_dwordx4 v2, s[8:11], s36 offen lds
  s_add_u32 m0, s35, 19456
  s_add_u32 s36, s32, 12928
  buffer_load_dwordx4 v3, s[8:11], s36 offen lds
  s_add_u32 s36, s33, 983040
  s_add_u32 m0, s38, 12288
  s_nop 0
  buffer_load_dwordx4 v4, s[12:15], s36 offen lds
  s_add_u32 m0, s38, 13312
  s_nop 0
  buffer_load_dwordx4 v5, s[12:15], s36 offen lds
  s_add_u32 m0, s38, 14336
  s_nop 0
  buffer_load_dwordx4 v6, s[12:15], s36 offen lds
  s_waitcnt vmcnt(7)
  s_barrier
  s_add_u32 m0, s35, 32768
  s_add_u32 s36, s32, 768
  buffer_load_dwordx4 v2, s[8:11], s36 offen lds
  s_add_u32 m0, s35, 33792
  s_add_u32 s36, s32, 4864
  buffer_load_dwordx4 v3, s[8:11], s36 offen lds
  s_add_u32 m0, s35, 34816
  s_add_u32 s36, s32, 8960
  buffer_load_dwordx4 v2, s[8:11], s36 offen lds
  s_add_u32 m0, s35, 35840
  s_add_u32 s36, s32, 13056
  buffer_load_dwordx4 v3, s[8:11], s36 offen lds
  s_add_u32 s36, s33, 1179648
  s_add_u32 m0, s38, 24576
  s_nop 0
  buffer_load_dwordx4 v4, s[12:15], s36 offen lds
  s_add_u32 m0, s38, 25600
  s_nop 0
  buffer_load_dwordx4 v5, s[12:15], s36 offen lds
  s_add_u32 m0, s38, 26624
  s_nop 0
  buffer_load_dwordx4 v6, s[12:15], s36 offen lds
  s_waitcnt vmcnt(7)
  s_barrier
  s_add_u32 m0, s35, 49152
  s_add_u32 s36, s32, 896
  buffer_load_dwordx4 v2, s[8:11], s36 offen lds
  s_add_u32 m0, s35, 50176
  s_add_u32 s36, s32, 4992
  buffer_load_dwordx4 v3, s[8:11], s36 offen lds
  s_add_u32 m0, s35, 51200
  s_add_u32 s36, s32, 9088
  buffer_load_dwordx4 v2, s[8:11], s36 offen lds
  s_add_u32 m0, s35, 52224
  s_add_u32 s36, s32, 13184
  buffer_load_dwordx4 v3, s[8:11], s36 offen lds
  s_add_u32 s36, s33, 1376256
  s_add_u32 m0, s38, 36864
  s_nop 0
  buffer_load_dwordx4 v4, s[12:15], s36 offen lds
  s_add_u32 m0, s38, 37888
  s_nop 0
  buffer_load_dwordx4 v5, s[12:15], s36 offen lds
  s_add_u32 m0, s38, 38912
  s_nop 0
  buffer_load_dwordx4 v6, s[12:15], s36 offen lds
  s_waitcnt vmcnt(7)
  s_barrier
  s_add_u32 m0, s35, 0
  s_add_u32 s36, s32, 0
  buffer_load_dwordx4 v2, s[8:11], s36 offen lds
  s_add_u32 m0, s35, 1024
  s_add_u32 s36, s32, 4096
  buffer_load_dwordx4 v3, s[8:11], s36 offen lds
  s_add_u32 m0, s35, 2048
  s_add_u32 s36, s32, 8192
  buffer_load_dwordx4 v2, s[8:11], s36 offen lds
  s_add_u32 m0, s35, 3072
  s_add_u32 s36, s32, 12288
  buffer_load_dwordx4 v3, s[8:11], s36 offen lds
  s_add_u32 s36, s34, 0
  s_add_u32 m0, s39, 0
  s_nop 0
  buffer_load_dwordx4 v7, s[16:19], s36 offen lds
  s_add_u32 m0, s39, 4096
  s_nop 0
  buffer_load_dwordx4 v7, s[20:23], s36 offen lds
  s_waitcnt vmcnt(6)
  s_barrier
  s_add_u32 m0, s35, 16384
  s_add_u32 s36, s32, 128
  buffer_load_dwordx4 v2, s[8:11], s36 offen lds
  s_add_u32 m0, s35, 17408
  s_add_u32 s36, s32, 4224
  buffer_load_dwordx4 v3, s[8:11], s36 offen lds
  s_add_u32 m0, s35, 18432
  s_add_u32 s36, s32, 8320
  buffer_load_dwordx4 v2, s[8:11], s36 offen lds
  s_add_u32 m0, s35, 19456
  s_add_u32 s36, s32, 12416
  buffer_load_dwordx4 v3, s[8:11], s36 offen lds
  s_add_u32 s36, s34, 128
  s_add_u32 m0, s39, 12288
  s_nop 0
  buffer_load_dwordx4 v7, s[16:19], s36 offen lds
  s_add_u32 m0, s39, 16384
  s_nop 0
  buffer_load_dwordx4 v7, s[20:23], s36 offen lds
  s_waitcnt vmcnt(6)
  s_barrier
  s_add_u32 m0, s35, 32768
  s_add_u32 s36, s32, 256
  buffer_load_dwordx4 v2, s[8:11], s36 offen lds
  s_add_u32 m0, s35, 33792
  s_add_u32 s36, s32, 4352
  buffer_load_dwordx4 v3, s[8:11], s36 offen lds
  s_add_u32 m0, s35, 34816
  s_add_u32 s36, s32, 8448
  buffer_load_dwordx4 v2, s[8:11], s36 offen lds
  s_add_u32 m0, s35, 35840
  s_add_u32 s36, s32, 12544
  buffer_load_dwordx4 v3, s[8:11], s36 offen lds
  s_add_u32 s36, s34, 256
  s_add_u32 m0, s39, 24576
  s_nop 0
  buffer_load_dwordx4 v7, s[16:19], s36 offen lds
  s_add_u32 m0, s39, 28672
  s_nop 0
  buffer_load_dwordx4 v7, s[20:23], s36 offen lds
  s_waitcnt vmcnt(6)
  s_barrier
  s_add_u32 m0, s35, 49152
  s_add_u32 s36, s32, 384
  buffer_load_dwordx4 v2, s[8:11], s36 offen lds
  s_add_u32 m0, s35, 50176
  s_add_u32 s36, s32, 4480
  buffer_load_dwordx4 v3, s[8:11], s36 offen lds
  s_add_u32 m0, s35, 51200
  s_add_u32 s36, s32, 8576
  buffer_load_dwordx4 v2, s[8:11], s36 offen lds
  s_add_u32 m0, s35, 52224
  s_add_u32 s36, s32, 12672
  buffer_load_dwordx4 v3, s[8:11], s36 offen lds
  s_add_u32 s36, s34, 384
  s_add_u32 m0, s39, 36864
  s_nop 0
  buffer_load_dwordx4 v7, s[16:19], s36 offen lds
  s_add_u32 m0, s39, 40960
  s_nop 0
  buffer_load_dwordx4 v7, s[20:23], s36 offen lds
  s_waitcnt vmcnt(6)
  s_barrier
  s_add_u32 m0, s35, 0
  s_add_u32 s36, s32, 512
  buffer_load_dwordx4 v2, s[8:11], s36 offen lds
  s_add_u32 m0, s35, 1024
  s_add_u32 s36, s32, 4608
  buffer_load_dwordx4 v3, s[8:11], s36 offen lds
  s_add_u32 m0, s35, 2048
  s_add_u32 s36, s32, 8704
  buffer_load_dwordx4 v2, s[8:11], s36 offen lds
  s_add_u32 m0, s35, 3072
  s_add_u32 s36, s32, 12800
  buffer_load_dwordx4 v3, s[8:11], s36 offen lds
  s_add_u32 s36, s34, 512
  s_add_u32 m0, s39, 0
  s_nop 0
  buffer_load_dwordx4 v7, s[16:19], s36 offen lds
  s_add_u32 m0, s39, 4096
  s_nop 0
  buffer_load_dwordx4 v7, s[20:23], s36 offen lds
  s_waitcnt vmcnt(6)
  s_barrier
  s_add_u32 m0, s35, 16384
  s_add_u32 s36, s32, 640
  buffer_load_dwordx4 v2, s[8:11], s36 offen lds
  s_add_u32 m0, s35, 17408
  s_add_u32 s36, s32, 4736
  buffer_load_dwordx4 v3, s[8:11], s36 offen lds
  s_add_u32 m0, s35, 18432
  s_add_u32 s36, s32, 8832
  buffer_load_dwordx4 v2, s[8:11], s36 offen lds
  s_add_u32 m0, s35, 19456
  s_add_u32 s36, s32, 12928
  buffer_load_dwordx4 v3, s[8:11], s36 offen lds
  s_add_u32 s36, s34, 640
  s_add_u32 m0, s39, 12288
  s_nop 0
  buffer_load_dwordx4 v7, s[16:19], s36 offen lds
  s_add_u32 m0, s39, 16384
  s_nop 0
  buffer_load_dwordx4 v7, s[20:23], s36 offen lds
  s_waitcnt vmcnt(6)
  s_barrier
  s_add_u32 m0, s35, 32768
  s_add_u32 s36, s32, 768
  buffer_load_dwordx4 v2, s[8:11], s36 offen lds
  s_add_u32 m0, s35, 33792
  s_add_u32 s36, s32, 4864
  buffer_load_dwordx4 v3, s[8:11], s36 offen lds
  s_add_u32 m0, s35, 34816
  s_add_u32 s36, s32, 8960
  buffer_load_dwordx4 v2, s[8:11], s36 offen lds
  s_add_u32 m0, s35, 35840
  s_add_u32 s36, s32, 13056
  buffer_load_dwordx4 v3, s[8:11], s36 offen lds
  s_add_u32 s36, s34, 768
  s_add_u32 m0, s39, 24576
  s_nop 0
  buffer_load_dwordx4 v7, s[16:19], s36 offen lds
  s_add_u32 m0, s39, 28672
  s_nop 0
  buffer_load_dwordx4 v7, s[20:23], s36 offen lds
  s_waitcnt vmcnt(6)
  s_barrier
  s_add_u32 m0, s35, 49152
  s_add_u32 s36, s32, 896
  buffer_load_dwordx4 v2, s[8:11], s36 offen lds
  s_add_u32 m0, s35, 50176
  s_add_u32 s36, s32, 4992
  buffer_load_dwordx4 v3, s[8:11], s36 offen lds
  s_add_u32 m0, s35, 51200
  s_add_u32 s36, s32, 9088
  buffer_load_dwordx4 v2, s[8:11], s36 offen lds
  s_add_u32 m0, s35, 52224
  s_add_u32 s36, s32, 13184
  buffer_load_dwordx4 v3, s[8:11], s36 offen lds
  s_add_u32 s36, s34, 896
  s_add_u32 m0, s39, 36864
  s_nop 0
  buffer_load_dwordx4 v7, s[16:19], s36 offen lds
  s_add_u32 m0, s39, 40960
  s_nop 0
  buffer_load_dwordx4 v7, s[20:23], s36 offen lds
  s_waitcnt vmcnt(6)
  s_barrier
  s_waitcnt vmcnt(0)
  s_barrier
  s_barrier
  ds_read2_b32 v[24:25], v206 offset0:0 offset1:16
  ds_read2_b32 v[26:27], v206 offset0:1 offset1:17
  ds_read2_b32 v[28:29], v206 offset0:2 offset1:18
  ds_read2_b32 v[30:31], v206 offset0:3 offset1:19
  ds_read2_b32 v[32:33], v207 offset0:0 offset1:16
  ds_read2_b32 v[34:35], v207 offset0:1 offset1:17
  ds_read2_b32 v[36:37], v207 offset0:2 offset1:18
  ds_read2_b32 v[38:39], v207 offset0:3 offset1:19
  ds_read2_b32 v[40:41], v208 offset0:0 offset1:16
  ds_read2_b32 v[42:43], v208 offset0:1 offset1:17
  ds_read2_b32 v[44:45], v208 offset0:2 offset1:18
  ds_read2_b32 v[46:47], v208 offset0:3 offset1:19
  s_waitcnt lgkmcnt(4)
  ds_read2_b32 v[48:49], v209 offset0:0 offset1:16
  ds_read2_b32 v[50:51], v209 offset0:1 offset1:17
  ds_read2_b32 v[52:53], v209 offset0:2 offset1:18
  ds_read2_b32 v[54:55], v209 offset0:3 offset1:19
  s_lshl_b32 s36, s29, 4
  s_add_u32 s36, s36, s28
  s_lshl_b32 s36, s36, 2
  s_add_u32 s36, s36, s31
  s_lshl_b32 s36, s36, 3
  s_add_u32 s36, s36, 21037056
  s_mov_b32 exec_lo, 0
  s_mov_b32 exec_hi, 0x80000000
  buffer_store_dwordx2 v[216:217], v213, s[4:7], s36 offen sc1
  s_mov_b64 exec, -1
  s_lshl_b32 s96, s29, 2
  s_add_u32 s96, s96, s31
  s_lshl_b32 s96, s96, 4
  s_add_u32 s96, s96, s28
  s_lshl_b32 s96, s96, 11
  s_add_u32 s96, s96, 6291456
  buffer_store_dwordx4 v[144:147], v1, s[4:7], s96 offen sc1
  buffer_store_dwordx4 v[144:147], v1, s[4:7], s96 offen offset:1024 sc1
  s_waitcnt lgkmcnt(0)
  v_mov_b32 v172, 139264
  v_mov_b32 v173, 1
  s_mov_b64 exec, 1
  ds_add_u32 v172, v173
  s_mov_b64 exec, -1
  s_setprio 1
  v_mov_b32 v84, v24
  v_mov_b32 v85, v25
  v_pk_fma_f32 v[86:87], v[56:57], v[84:85], v[26:27] op_sel:[1,1,0] op_sel_hi:[1,0,1] neg_lo:[1,0,0]
  v_pk_fma_f32 v[84:85], v[56:57], v[84:85], v[86:87] op_sel:[0,0,0] op_sel_hi:[0,1,1]
  v_pk_fma_f32 v[86:87], v[56:57], v[84:85], v[28:29] op_sel:[1,1,0] op_sel_hi:[1,0,1] neg_lo:[1,0,0]
  v_pk_fma_f32 v[84:85], v[56:57], v[84:85], v[86:87] op_sel:[0,0,0] op_sel_hi:[0,1,1]
  v_pk_fma_f32 v[86:87], v[56:57], v[84:85], v[30:31] op_sel:[1,1,0] op_sel_hi:[1,0,1] neg_lo:[1,0,0]
  v_pk_fma_f32 v[84:85], v[56:57], v[84:85], v[86:87] op_sel:[0,0,0] op_sel_hi:[0,1,1]
  v_pk_fma_f32 v[86:87], v[56:57], v[84:85], v[32:33] op_sel:[1,1,0] op_sel_hi:[1,0,1] neg_lo:[1,0,0]
  v_pk_fma_f32 v[84:85], v[56:57], v[84:85], v[86:87] op_sel:[0,0,0] op_sel_hi:[0,1,1]
  v_pk_fma_f32 v[86:87], v[56:57], v[84:85], v[34:35] op_sel:[1,1,0] op_sel_hi:[1,0,1] neg_lo:[1,0,0]
  v_pk_fma_f32 v[84:85], v[56:57], v[84:85], v[86:87] op_sel:[0,0,0] op_sel_hi:[0,1,1]
  v_pk_fma_f32 v[86:87], v[56:57], v[84:85], v[36:37] op_sel:[1,1,0] op_sel_hi:[1,0,1] neg_lo:[1,0,0]
  v_pk_fma_f32 v[84:85], v[56:57], v[84:85], v[86:87] op_sel:[0,0,0] op_sel_hi:[0,1,1]
  v_pk_fma_f32 v[86:87], v[56:57], v[84:85], v[38:39] op_sel:[1,1,0] op_sel_hi:[1,0,1] neg_lo:[1,0,0]
  v_pk_fma_f32 v[84:85], v[56:57], v[84:85], v[86:87] op_sel:[0,0,0] op_sel_hi:[0,1,1]
  v_pk_fma_f32 v[86:87], v[56:57], v[84:85], v[40:41] op_sel:[1,1,0] op_sel_hi:[1,0,1] neg_lo:[1,0,0]
  v_pk_fma_f32 v[84:85], v[56:57], v[84:85], v[86:87] op_sel:[0,0,0] op_sel_hi:[0,1,1]
  v_pk_fma_f32 v[86:87], v[56:57], v[84:85], v[42:43] op_sel:[1,1,0] op_sel_hi:[1,0,1] neg_lo:[1,0,0]
  v_pk_fma_f32 v[84:85], v[56:57], v[84:85], v[86:87] op_sel:[0,0,0] op_sel_hi:[0,1,1]
  v_pk_fma_f32 v[86:87], v[56:57], v[84:85], v[44:45] op_sel:[1,1,0] op_sel_hi:[1,0,1] neg_lo:[1,0,0]
  v_pk_fma_f32 v[84:85], v[56:57], v[84:85], v[86:87] op_sel:[0,0,0] op_sel_hi:[0,1,1]
  v_pk_fma_f32 v[86:87], v[56:57], v[84:85], v[46:47] op_sel:[1,1,0] op_sel_hi:[1,0,1] neg_lo:[1,0,0]
  v_pk_fma_f32 v[84:85], v[56:57], v[84:85], v[86:87] op_sel:[0,0,0] op_sel_hi:[0,1,1]
  v_pk_fma_f32 v[86:87], v[56:57], v[84:85], v[48:49] op_sel:[1,1,0] op_sel_hi:[1,0,1] neg_lo:[1,0,0]
  v_pk_fma_f32 v[84:85], v[56:57], v[84:85], v[86:87] op_sel:[0,0,0] op_sel_hi:[0,1,1]
  v_pk_fma_f32 v[86:87], v[56:57], v[84:85], v[50:51] op_sel:[1,1,0] op_sel_hi:[1,0,1] neg_lo:[1,0,0]
  v_pk_fma_f32 v[84:85], v[56:57], v[84:85], v[86:87] op_sel:[0,0,0] op_sel_hi:[0,1,1]
  v_pk_fma_f32 v[86:87], v[56:57], v[84:85], v[52:53] op_sel:[1,1,0] op_sel_hi:[1,0,1] neg_lo:[1,0,0]
  v_pk_fma_f32 v[84:85], v[56:57], v[84:85], v[86:87] op_sel:[0,0,0] op_sel_hi:[0,1,1]
  v_pk_fma_f32 v[86:87], v[56:57], v[84:85], v[54:55] op_sel:[1,1,0] op_sel_hi:[1,0,1] neg_lo:[1,0,0]
  v_pk_fma_f32 v[84:85], v[56:57], v[84:85], v[86:87] op_sel:[0,0,0] op_sel_hi:[0,1,1]
  v_mov_b32 v94, v84
  v_mov_b32 v95, v85
  s_nop 1
  v_mov_b32_dpp v86, v84 row_shr:1 row_mask:0xf bank_mask:0xf bound_ctrl:1
  v_mov_b32_dpp v87, v85 row_shr:1 row_mask:0xf bank_mask:0xf bound_ctrl:1
  v_pk_fma_f32 v[84:85], v[200:201], v[86:87], v[84:85] op_sel:[0,0,0] op_sel_hi:[0,1,1]
  v_pk_fma_f32 v[84:85], v[200:201], v[86:87], v[84:85] op_sel:[1,1,0] op_sel_hi:[1,0,1] neg_lo:[1,0,0]
  s_nop 1
  v_mov_b32_dpp v86, v84 row_shr:2 row_mask:0xf bank_mask:0xf bound_ctrl:1
  v_mov_b32_dpp v87, v85 row_shr:2 row_mask:0xf bank_mask:0xf bound_ctrl:1
  v_pk_fma_f32 v[84:85], v[202:203], v[86:87], v[84:85] op_sel:[0,0,0] op_sel_hi:[0,1,1]
  v_pk_fma_f32 v[84:85], v[202:203], v[86:87], v[84:85] op_sel:[1,1,0] op_sel_hi:[1,0,1] neg_lo:[1,0,0]
  s_nop 1
  v_mov_b32_dpp v86, v84 row_shr:4 row_mask:0xf bank_mask:0xf bound_ctrl:1
  v_mov_b32_dpp v87, v85 row_shr:4 row_mask:0xf bank_mask:0xf bound_ctrl:1
  v_pk_fma_f32 v[84:85], v[204:205], v[86:87], v[84:85] op_sel:[0,0,0] op_sel_hi:[0,1,1]
  v_pk_fma_f32 v[84:85], v[204:205], v[86:87], v[84:85] op_sel:[1,1,0] op_sel_hi:[1,0,1] neg_lo:[1,0,0]
  s_lshl_b32 s96, s29, 12
  s_add_u32 s96, s96, 20971520
  s_mov_b32 exec_lo, 0x80808080
  s_mov_b32 exec_hi, 0x80808080
  buffer_store_dwordx2 v[84:85], v212, s[4:7], s96 offen sc1
  s_mov_b64 exec, -1
  s_waitcnt vmcnt(0)
  s_lshl_b32 s96, s28, 2
  s_add_u32 s96, s96, s31
  s_lshl_b32 s97, s96, 11
  s_add_u32 s97, s97, 23003136
  s_lshl_b32 s96, s29, 7
  s_add_u32 s96, s96, s97
  s_mov_b64 exec, 1
  v_mov_b32 v172, s24
  v_mov_b32 v173, s25
  buffer_store_dwordx2 v[172:173], v213, s[4:7], s96 offen sc1
  s_mov_b64 exec, -1
  s_cmp_lg_u32 s31, 3
  s_cbranch_scc1 L_f_noprep
  v_and_b32 v128, 31, v0
  v_lshlrev_b32 v128, 10, v128
  v_lshrrev_b32 v129, 5, v0
  s_lshl_b32 s96, s2, 2
  s_add_u32 s96, s96, 0
  s_lshr_b32 s97, s96, 6
  s_lshl_b32 s97, s97, 15
  s_and_b32 s98, s96, 63
  s_lshl_b32 s98, s98, 4
  s_add_u32 s97, s97, s98
  s_mov_b32 exec_lo, -1
  s_mov_b32 exec_hi, 0
  buffer_load_dwordx4 v[132:135], v128, s[56:59], s97 offen
  s_mov_b32 exec_lo, 0
  s_mov_b32 exec_hi, -1
  buffer_load_dwordx4 v[132:135], v128, s[60:63], s97 offen
  s_lshl_b32 s96, s2, 2
  s_add_u32 s96, s96, 1
  s_lshr_b32 s97, s96, 6
  s_lshl_b32 s97, s97, 15
  s_and_b32 s98, s96, 63
  s_lshl_b32 s98, s98, 4
  s_add_u32 s97, s97, s98
  s_mov_b32 exec_lo, -1
  s_mov_b32 exec_hi, 0
  buffer_load_dwordx4 v[136:139], v128, s[56:59], s97 offen
  s_mov_b32 exec_lo, 0
  s_mov_b32 exec_hi, -1
  buffer_load_dwordx4 v[136:139], v128, s[60:63], s97 offen
  s_lshl_b32 s96, s2, 2
  s_add_u32 s96, s96, 2
  s_lshr_b32 s97, s96, 6
  s_lshl_b32 s97, s97, 15
  s_and_b32 s98, s96, 63
  s_lshl_b32 s98, s98, 4
  s_add_u32 s97, s97, s98
  s_mov_b32 exec_lo, -1
  s_mov_b32 exec_hi, 0
  buffer_load_dwordx4 v[140:143], v128, s[56:59], s97 offen
  s_mov_b32 exec_lo, 0
  s_mov_b32 exec_hi, -1
  buffer_load_dwordx4 v[140:143], v128, s[60:63], s97 offen
  s_lshl_b32 s96, s2, 2
  s_add_u32 s96, s96, 3
  s_lshr_b32 s97, s96, 6
  s_lshl_b32 s97, s97, 15
  s_and_b32 s98, s96, 63
  s_lshl_b32 s98, s98, 4
  s_add_u32 s97, s97, s98
  s_mov_b32 exec_lo, -1
  s_mov_b32 exec_hi, 0
  buffer_load_dwordx4 v[144:147], v128, s[56:59], s97 offen
  s_mov_b32 exec_lo, 0
  s_mov_b32 exec_hi, -1
  buffer_load_dwordx4 v[144:147], v128, s[60:63], s97 offen
  s_mov_b64 exec, -1
  v_and_b32 v130, 31, v0
  v_lshlrev_b32 v130, 1, v130
  v_lshl_add_u32 v130, v129, 12, v130
  s_lshl_b32 s96, s2, 1
  s_add_u32 s96, s96, 0
  s_lshr_b32 s97, s96, 5
  s_lshl_b32 s97, s97, 6
  s_and_b32 s98, s96, 31
  s_lshl_b32 s98, s98, 14
  s_add_u32 s97, s97, s98
  s_add_u32 s99, s97, 0
  buffer_load_ushort v156, v130, s[64:67], s99 offen
  s_add_u32 s99, s97, 1024
  buffer_load_ushort v157, v130, s[64:67], s99 offen
  s_add_u32 s99, s97, 2048
  buffer_load_ushort v158, v130, s[64:67], s99 offen
  s_add_u32 s99, s97, 3072
  buffer_load_ushort v159, v130, s[64:67], s99 offen
  s_add_u32 s99, s97, 8192
  buffer_load_ushort v160, v130, s[64:67], s99 offen
  s_add_u32 s99, s97, 9216
  buffer_load_ushort v161, v130, s[64:67], s99 offen
  s_add_u32 s99, s97, 10240
  buffer_load_ushort v162, v130, s[64:67], s99 offen
  s_add_u32 s99, s97, 11264
  buffer_load_ushort v163, v130, s[64:67], s99 offen
  s_lshl_b32 s96, s2, 1
  s_add_u32 s96, s96, 1
  s_lshr_b32 s97, s96, 5
  s_lshl_b32 s97, s97, 6
  s_and_b32 s98, s96, 31
  s_lshl_b32 s98, s98, 14
  s_add_u32 s97, s97, s98
  s_add_u32 s99, s97, 0
  buffer_load_ushort v164, v130, s[64:67], s99 offen
  s_add_u32 s99, s97, 1024
  buffer_load_ushort v165, v130, s[64:67], s99 offen
  s_add_u32 s99, s97, 2048
  buffer_load_ushort v166, v130, s[64:67], s99 offen
  s_add_u32 s99, s97, 3072
  buffer_load_ushort v167, v130, s[64:67], s99 offen
  s_add_u32 s99, s97, 8192
  buffer_load_ushort v168, v130, s[64:67], s99 offen
  s_add_u32 s99, s97, 9216
  buffer_load_ushort v169, v130, s[64:67], s99 offen
  s_add_u32 s99, s97, 10240
  buffer_load_ushort v170, v130, s[64:67], s99 offen
  s_add_u32 s99, s97, 11264
  buffer_load_ushort v171, v130, s[64:67], s99 offen
  s_waitcnt vmcnt(0)
  v_lshl_or_b32 v148, v157, 16, v156
  v_lshl_or_b32 v149, v159, 16, v158
  v_lshl_or_b32 v150, v161, 16, v160
  v_lshl_or_b32 v151, v163, 16, v162
  v_lshl_or_b32 v152, v165, 16, v164
  v_lshl_or_b32 v153, v167, 16, v166
  v_lshl_or_b32 v154, v169, 16, v168
  v_lshl_or_b32 v155, v171, 16, v170
  s_lshl_b32 s96, s2, 12
  s_add_u32 s96, s96, 21102592
  buffer_store_dwordx4 v[132:135], v1, s[4:7], s96 offen sc1
  s_lshl_b32 s96, s2, 12
  s_add_u32 s96, s96, 21103616
  buffer_store_dwordx4 v[136:139], v1, s[4:7], s96 offen sc1
  s_lshl_b32 s96, s2, 12
  s_add_u32 s96, s96, 21104640
  buffer_store_dwordx4 v[140:143], v1, s[4:7], s96 offen sc1
  s_lshl_b32 s96, s2, 12
  s_add_u32 s96, s96, 21105664
  buffer_store_dwordx4 v[144:147], v1, s[4:7], s96 offen sc1
  s_lshl_b32 s96, s2, 11
  s_add_u32 s96, s96, 22151168
  buffer_store_dwordx4 v[148:151], v1, s[4:7], s96 offen sc1
  s_lshl_b32 s96, s2, 11
  s_add_u32 s96, s96, 22152192
  buffer_store_dwordx4 v[152:155], v1, s[4:7], s96 offen sc1
  s_waitcnt vmcnt(0)
  s_lshl_b32 s96, s2, 7
  s_add_u32 s96, s96, 22937600
  s_mov_b64 exec, 1
  v_mov_b32 v172, s24
  v_mov_b32 v173, s25
  v_mov_b32 v174, 0
  buffer_store_dwordx2 v[172:173], v174, s[4:7], s96 offen sc1
  s_mov_b64 exec, -1
L_f_noprep:
  v_mov_b32 v92, 0
  v_mov_b32 v93, 0
  s_cmp_eq_u32 s29, 0
  s_cbranch_scc1 L_f_noewait
  s_lshl_b32 s96, s28, 2
  s_add_u32 s96, s96, s31
  s_lshl_b32 s96, s96, 11
  s_add_u32 s96, s96, 23003136
  s_bfm_b32 s97, s29, 0
  s_mov_b32 exec_lo, s97
  s_mov_b32 exec_hi, 0
  s_mov_b32 s26, 400000
L_poll_e:
  buffer_load_dwordx2 v[178:179], v214, s[4:7], s96 offen sc1
  s_waitcnt vmcnt(0)
  v_cmp_ne_u32 vcc, s24, v178
  v_cmp_ne_u32 s[36:37], s25, v179
  s_or_b64 vcc, vcc, s[36:37]
  s_cbranch_vccz L_polld_e
  s_sub_u32 s26, s26, 1
  s_cbranch_scc1 L_polld_e
  s_sleep 4
  s_branch L_poll_e
L_polld_e:
  s_mov_b64 exec, -1
  s_mov_b32 s96, 20971520
  buffer_load_dwordx2 v[96:97], v212, s[4:7], s96 offen sc1
  s_add_u32 s96, s96, 4096
  buffer_load_dwordx2 v[98:99], v212, s[4:7], s96 offen sc1
  s_add_u32 s96, s96, 4096
  buffer_load_dwordx2 v[100:101], v212, s[4:7], s96 offen sc1
  s_add_u32 s96, s96, 4096
  buffer_load_dwordx2 v[102:103], v212, s[4:7], s96 offen sc1
  s_add_u32 s96, s96, 4096
  buffer_load_dwordx2 v[104:105], v212, s[4:7], s96 offen sc1
  s_add_u32 s96, s96, 4096
  buffer_load_dwordx2 v[106:107], v212, s[4:7], s96 offen sc1
  s_add_u32 s96, s96, 4096
  buffer_load_dwordx2 v[108:109], v212, s[4:7], s96 offen sc1
  s_add_u32 s96, s96, 4096
  buffer_load_dwordx2 v[110:111], v212, s[4:7], s96 offen sc1
  s_add_u32 s96, s96, 4096
  buffer_load_dwordx2 v[112:113], v212, s[4:7], s96 offen sc1
  s_add_u32 s96, s96, 4096
  buffer_load_dwordx2 v[114:115], v212, s[4:7], s96 offen sc1
  s_add_u32 s96, s96, 4096
  buffer_load_dwordx2 v[116:117], v212, s[4:7], s96 offen sc1
  s_add_u32 s96, s96, 4096
  buffer_load_dwordx2 v[118:119], v212, s[4:7], s96 offen sc1
  s_add_u32 s96, s96, 4096
  buffer_load_dwordx2 v[120:121], v212, s[4:7], s96 offen sc1
  s_add_u32 s96, s96, 4096
  buffer_load_dwordx2 v[122:123], v212, s[4:7], s96 offen sc1
  s_add_u32 s96, s96, 4096
  buffer_load_dwordx2 v[124:125], v212, s[4:7], s96 offen sc1
  s_add_u32 s96, s96, 4096
  s_waitcnt vmcnt(0)
  v_pk_fma_f32 v[86:87], v[66:67], v[92:93], v[96:97] op_sel:[1,1,0] op_sel_hi:[1,0,1] neg_lo:[1,0,0]
  v_pk_fma_f32 v[92:93], v[66:67], v[92:93], v[86:87] op_sel:[0,0,0] op_sel_hi:[0,1,1]
  s_cmp_le_u32 s29, 1
  s_cbranch_scc1 L_f_noewait
  v_pk_fma_f32 v[86:87], v[66:67], v[92:93], v[98:99] op_sel:[1,1,0] op_sel_hi:[1,0,1] neg_lo:[1,0,0]
  v_pk_fma_f32 v[92:93], v[66:67], v[92:93], v[86:87] op_sel:[0,0,0] op_sel_hi:[0,1,1]
  s_cmp_le_u32 s29, 2
  s_cbranch_scc1 L_f_noewait
  v_pk_fma_f32 v[86:87], v[66:67], v[92:93], v[100:101] op_sel:[1,1,0] op_sel_hi:[1,0,1] neg_lo:[1,0,0]
  v_pk_fma_f32 v[92:93], v[66:67], v[92:93], v[86:87] op_sel:[0,0,0] op_sel_hi:[0,1,1]
  s_cmp_le_u32 s29, 3
  s_cbranch_scc1 L_f_noewait
  v_pk_fma_f32 v[86:87], v[66:67], v[92:93], v[102:103] op_sel:[1,1,0] op_sel_hi:[1,0,1] neg_lo:[1,0,0]
  v_pk_fma_f32 v[92:93], v[66:67], v[92:93], v[86:87] op_sel:[0,0,0] op_sel_hi:[0,1,1]
  s_cmp_le_u32 s29, 4
  s_cbranch_scc1 L_f_noewait
  v_pk_fma_f32 v[86:87], v[66:67], v[92:93], v[104:105] op_sel:[1,1,0] op_sel_hi:[1,0,1] neg_lo:[1,0,0]
  v_pk_fma_f32 v[92:93], v[66:67], v[92:93], v[86:87] op_sel:[0,0,0] op_sel_hi:[0,1,1]
  s_cmp_le_u32 s29, 5
  s_cbranch_scc1 L_f_noewait
  v_pk_fma_f32 v[86:87], v[66:67], v[92:93], v[106:107] op_sel:[1,1,0] op_sel_hi:[1,0,1] neg_lo:[1,0,0]
  v_pk_fma_f32 v[92:93], v[66:67], v[92:93], v[86:87] op_sel:[0,0,0] op_sel_hi:[0,1,1]
  s_cmp_le_u32 s29, 6
  s_cbranch_scc1 L_f_noewait
  v_pk_fma_f32 v[86:87], v[66:67], v[92:93], v[108:109] op_sel:[1,1,0] op_sel_hi:[1,0,1] neg_lo:[1,0,0]
  v_pk_fma_f32 v[92:93], v[66:67], v[92:93], v[86:87] op_sel:[0,0,0] op_sel_hi:[0,1,1]
  s_cmp_le_u32 s29, 7
  s_cbranch_scc1 L_f_noewait
  v_pk_fma_f32 v[86:87], v[66:67], v[92:93], v[110:111] op_sel:[1,1,0] op_sel_hi:[1,0,1] neg_lo:[1,0,0]
  v_pk_fma_f32 v[92:93], v[66:67], v[92:93], v[86:87] op_sel:[0,0,0] op_sel_hi:[0,1,1]
  s_cmp_le_u32 s29, 8
  s_cbranch_scc1 L_f_noewait
  v_pk_fma_f32 v[86:87], v[66:67], v[92:93], v[112:113] op_sel:[1,1,0] op_sel_hi:[1,0,1] neg_lo:[1,0,0]
  v_pk_fma_f32 v[92:93], v[66:67], v[92:93], v[86:87] op_sel:[0,0,0] op_sel_hi:[0,1,1]
  s_cmp_le_u32 s29, 9
  s_cbranch_scc1 L_f_noewait
  v_pk_fma_f32 v[86:87], v[66:67], v[92:93], v[114:115] op_sel:[1,1,0] op_sel_hi:[1,0,1] neg_lo:[1,0,0]
  v_pk_fma_f32 v[92:93], v[66:67], v[92:93], v[86:87] op_sel:[0,0,0] op_sel_hi:[0,1,1]
  s_cmp_le_u32 s29, 10
  s_cbranch_scc1 L_f_noewait
  v_pk_fma_f32 v[86:87], v[66:67], v[92:93], v[116:117] op_sel:[1,1,0] op_sel_hi:[1,0,1] neg_lo:[1,0,0]
  v_pk_fma_f32 v[92:93], v[66:67], v[92:93], v[86:87] op_sel:[0,0,0] op_sel_hi:[0,1,1]
  s_cmp_le_u32 s29, 11
  s_cbranch_scc1 L_f_noewait
  v_pk_fma_f32 v[86:87], v[66:67], v[92:93], v[118:119] op_sel:[1,1,0] op_sel_hi:[1,0,1] neg_lo:[1,0,0]
  v_pk_fma_f32 v[92:93], v[66:67], v[92:93], v[86:87] op_sel:[0,0,0] op_sel_hi:[0,1,1]
  s_cmp_le_u32 s29, 12
  s_cbranch_scc1 L_f_noewait
  v_pk_fma_f32 v[86:87], v[66:67], v[92:93], v[120:121] op_sel:[1,1,0] op_sel_hi:[1,0,1] neg_lo:[1,0,0]
  v_pk_fma_f32 v[92:93], v[66:67], v[92:93], v[86:87] op_sel:[0,0,0] op_sel_hi:[0,1,1]
  s_cmp_le_u32 s29, 13
  s_cbranch_scc1 L_f_noewait
  v_pk_fma_f32 v[86:87], v[66:67], v[92:93], v[122:123] op_sel:[1,1,0] op_sel_hi:[1,0,1] neg_lo:[1,0,0]
  v_pk_fma_f32 v[92:93], v[66:67], v[92:93], v[86:87] op_sel:[0,0,0] op_sel_hi:[0,1,1]
  s_cmp_le_u32 s29, 14
  s_cbranch_scc1 L_f_noewait
  v_pk_fma_f32 v[86:87], v[66:67], v[92:93], v[124:125] op_sel:[1,1,0] op_sel_hi:[1,0,1] neg_lo:[1,0,0]
  v_pk_fma_f32 v[92:93], v[66:67], v[92:93], v[86:87] op_sel:[0,0,0] op_sel_hi:[0,1,1]
L_f_noewait:
  v_mov_b32_dpp v86, v94 row_shr:1 row_mask:0xf bank_mask:0xf bound_ctrl:1
  v_mov_b32_dpp v87, v95 row_shr:1 row_mask:0xf bank_mask:0xf bound_ctrl:1
  v_cndmask_b32 v84, v86, v92, s[46:47]
  v_cndmask_b32 v85, v87, v93, s[46:47]
  s_nop 1
  v_mov_b32_dpp v86, v84 row_shr:1 row_mask:0xf bank_mask:0xf bound_ctrl:1
  v_mov_b32_dpp v87, v85 row_shr:1 row_mask:0xf bank_mask:0xf bound_ctrl:1
  v_pk_fma_f32 v[84:85], v[200:201], v[86:87], v[84:85] op_sel:[0,0,0] op_sel_hi:[0,1,1]
  v_pk_fma_f32 v[84:85], v[200:201], v[86:87], v[84:85] op_sel:[1,1,0] op_sel_hi:[1,0,1] neg_lo:[1,0,0]
  s_nop 1
  v_mov_b32_dpp v86, v84 row_shr:2 row_mask:0xf bank_mask:0xf bound_ctrl:1
  v_mov_b32_dpp v87, v85 row_shr:2 row_mask:0xf bank_mask:0xf bound_ctrl:1
  v_pk_fma_f32 v[84:85], v[202:203], v[86:87], v[84:85] op_sel:[0,0,0] op_sel_hi:[0,1,1]
  v_pk_fma_f32 v[84:85], v[202:203], v[86:87], v[84:85] op_sel:[1,1,0] op_sel_hi:[1,0,1] neg_lo:[1,0,0]
  s_nop 1
  v_mov_b32_dpp v86, v84 row_shr:4 row_mask:0xf bank_mask:0xf bound_ctrl:1
  v_mov_b32_dpp v87, v85 row_shr:4 row_mask:0xf bank_mask:0xf bound_ctrl:1
  v_pk_fma_f32 v[84:85], v[204:205], v[86:87], v[84:85] op_sel:[0,0,0] op_sel_hi:[0,1,1]
  v_pk_fma_f32 v[84:85], v[204:205], v[86:87], v[84:85] op_sel:[1,1,0] op_sel_hi:[1,0,1] neg_lo:[1,0,0]
  v_pk_fma_f32 v[86:87], v[56:57], v[84:85], v[24:25] op_sel:[1,1,0] op_sel_hi:[1,0,1] neg_lo:[1,0,0]
  v_pk_fma_f32 v[84:85], v[56:57], v[84:85], v[86:87] op_sel:[0,0,0] op_sel_hi:[0,1,1]
  v_pk_mul_f32 v[24:25], v[58:59], v[84:85] op_sel:[0,0] op_sel_hi:[0,1] neg_hi:[1,0]
  v_pk_fma_f32 v[24:25], v[58:59], v[84:85], v[24:25] op_sel:[1,1,0] op_sel_hi:[1,0,1] neg_lo:[1,0,0] neg_hi:[1,0,0]
  v_pk_fma_f32 v[86:87], v[56:57], v[84:85], v[26:27] op_sel:[1,1,0] op_sel_hi:[1,0,1] neg_lo:[1,0,0]
  v_pk_fma_f32 v[84:85], v[56:57], v[84:85], v[86:87] op_sel:[0,0,0] op_sel_hi:[0,1,1]
  v_pk_mul_f32 v[26:27], v[58:59], v[84:85] op_sel:[0,0] op_sel_hi:[0,1] neg_hi:[1,0]
  v_pk_fma_f32 v[26:27], v[58:59], v[84:85], v[26:27] op_sel:[1,1,0] op_sel_hi:[1,0,1] neg_lo:[1,0,0] neg_hi:[1,0,0]
  v_pk_fma_f32 v[86:87], v[56:57], v[84:85], v[28:29] op_sel:[1,1,0] op_sel_hi:[1,0,1] neg_lo:[1,0,0]
  v_pk_fma_f32 v[84:85], v[56:57], v[84:85], v[86:87] op_sel:[0,0,0] op_sel_hi:[0,1,1]
  v_pk_mul_f32 v[28:29], v[58:59], v[84:85] op_sel:[0,0] op_sel_hi:[0,1] neg_hi:[1,0]
  v_pk_fma_f32 v[28:29], v[58:59], v[84:85], v[28:29] op_sel:[1,1,0] op_sel_hi:[1,0,1] neg_lo:[1,0,0] neg_hi:[1,0,0]
  v_pk_fma_f32 v[86:87], v[56:57], v[84:85], v[30:31] op_sel:[1,1,0] op_sel_hi:[1,0,1] neg_lo:[1,0,0]
  v_pk_fma_f32 v[84:85], v[56:57], v[84:85], v[86:87] op_sel:[0,0,0] op_sel_hi:[0,1,1]
  v_pk_mul_f32 v[30:31], v[58:59], v[84:85] op_sel:[0,0] op_sel_hi:[0,1] neg_hi:[1,0]
  v_pk_fma_f32 v[30:31], v[58:59], v[84:85], v[30:31] op_sel:[1,1,0] op_sel_hi:[1,0,1] neg_lo:[1,0,0] neg_hi:[1,0,0]
  v_pk_fma_f32 v[86:87], v[56:57], v[84:85], v[32:33] op_sel:[1,1,0] op_sel_hi:[1,0,1] neg_lo:[1,0,0]
  v_pk_fma_f32 v[84:85], v[56:57], v[84:85], v[86:87] op_sel:[0,0,0] op_sel_hi:[0,1,1]
  v_pk_mul_f32 v[32:33], v[58:59], v[84:85] op_sel:[0,0] op_sel_hi:[0,1] neg_hi:[1,0]
  v_pk_fma_f32 v[32:33], v[58:59], v[84:85], v[32:33] op_sel:[1,1,0] op_sel_hi:[1,0,1] neg_lo:[1,0,0] neg_hi:[1,0,0]
  v_pk_fma_f32 v[86:87], v[56:57], v[84:85], v[34:35] op_sel:[1,1,0] op_sel_hi:[1,0,1] neg_lo:[1,0,0]
  v_pk_fma_f32 v[84:85], v[56:57], v[84:85], v[86:87] op_sel:[0,0,0] op_sel_hi:[0,1,1]
  v_pk_mul_f32 v[34:35], v[58:59], v[84:85] op_sel:[0,0] op_sel_hi:[0,1] neg_hi:[1,0]
  v_pk_fma_f32 v[34:35], v[58:59], v[84:85], v[34:35] op_sel:[1,1,0] op_sel_hi:[1,0,1] neg_lo:[1,0,0] neg_hi:[1,0,0]
  v_pk_fma_f32 v[86:87], v[56:57], v[84:85], v[36:37] op_sel:[1,1,0] op_sel_hi:[1,0,1] neg_lo:[1,0,0]
  v_pk_fma_f32 v[84:85], v[56:57], v[84:85], v[86:87] op_sel:[0,0,0] op_sel_hi:[0,1,1]
  v_pk_mul_f32 v[36:37], v[58:59], v[84:85] op_sel:[0,0] op_sel_hi:[0,1] neg_hi:[1,0]
  v_pk_fma_f32 v[36:37], v[58:59], v[84:85], v[36:37] op_sel:[1,1,0] op_sel_hi:[1,0,1] neg_lo:[1,0,0] neg_hi:[1,0,0]
  v_pk_fma_f32 v[86:87], v[56:57], v[84:85], v[38:39] op_sel:[1,1,0] op_sel_hi:[1,0,1] neg_lo:[1,0,0]
  v_pk_fma_f32 v[84:85], v[56:57], v[84:85], v[86:87] op_sel:[0,0,0] op_sel_hi:[0,1,1]
  v_pk_mul_f32 v[38:39], v[58:59], v[84:85] op_sel:[0,0] op_sel_hi:[0,1] neg_hi:[1,0]
  v_pk_fma_f32 v[38:39], v[58:59], v[84:85], v[38:39] op_sel:[1,1,0] op_sel_hi:[1,0,1] neg_lo:[1,0,0] neg_hi:[1,0,0]
  v_pk_fma_f32 v[86:87], v[56:57], v[84:85], v[40:41] op_sel:[1,1,0] op_sel_hi:[1,0,1] neg_lo:[1,0,0]
  v_pk_fma_f32 v[84:85], v[56:57], v[84:85], v[86:87] op_sel:[0,0,0] op_sel_hi:[0,1,1]
  v_pk_mul_f32 v[40:41], v[58:59], v[84:85] op_sel:[0,0] op_sel_hi:[0,1] neg_hi:[1,0]
  v_pk_fma_f32 v[40:41], v[58:59], v[84:85], v[40:41] op_sel:[1,1,0] op_sel_hi:[1,0,1] neg_lo:[1,0,0] neg_hi:[1,0,0]
  v_pk_fma_f32 v[86:87], v[56:57], v[84:85], v[42:43] op_sel:[1,1,0] op_sel_hi:[1,0,1] neg_lo:[1,0,0]
  v_pk_fma_f32 v[84:85], v[56:57], v[84:85], v[86:87] op_sel:[0,0,0] op_sel_hi:[0,1,1]
  v_pk_mul_f32 v[42:43], v[58:59], v[84:85] op_sel:[0,0] op_sel_hi:[0,1] neg_hi:[1,0]
  v_pk_fma_f32 v[42:43], v[58:59], v[84:85], v[42:43] op_sel:[1,1,0] op_sel_hi:[1,0,1] neg_lo:[1,0,0] neg_hi:[1,0,0]
  v_pk_fma_f32 v[86:87], v[56:57], v[84:85], v[44:45] op_sel:[1,1,0] op_sel_hi:[1,0,1] neg_lo:[1,0,0]
  v_pk_fma_f32 v[84:85], v[56:57], v[84:85], v[86:87] op_sel:[0,0,0] op_sel_hi:[0,1,1]
  v_pk_mul_f32 v[44:45], v[58:59], v[84:85] op_sel:[0,0] op_sel_hi:[0,1] neg_hi:[1,0]
  v_pk_fma_f32 v[44:45], v[58:59], v[84:85], v[44:45] op_sel:[1,1,0] op_sel_hi:[1,0,1] neg_lo:[1,0,0] neg_hi:[1,0,0]
  v_pk_fma_f32 v[86:87], v[56:57], v[84:85], v[46:47] op_sel:[1,1,0] op_sel_hi:[1,0,1] neg_lo:[1,0,0]
  v_pk_fma_f32 v[84:85], v[56:57], v[84:85], v[86:87] op_sel:[0,0,0] op_sel_hi:[0,1,1]
  v_pk_mul_f32 v[46:47], v[58:59], v[84:85] op_sel:[0,0] op_sel_hi:[0,1] neg_hi:[1,0]
  v_pk_fma_f32 v[46:47], v[58:59], v[84:85], v[46:47] op_sel:[1,1,0] op_sel_hi:[1,0,1] neg_lo:[1,0,0] neg_hi:[1,0,0]
  v_pk_fma_f32 v[86:87], v[56:57], v[84:85], v[48:49] op_sel:[1,1,0] op_sel_hi:[1,0,1] neg_lo:[1,0,0]
  v_pk_fma_f32 v[84:85], v[56:57], v[84:85], v[86:87] op_sel:[0,0,0] op_sel_hi:[0,1,1]
  v_pk_mul_f32 v[48:49], v[58:59], v[84:85] op_sel:[0,0] op_sel_hi:[0,1] neg_hi:[1,0]
  v_pk_fma_f32 v[48:49], v[58:59], v[84:85], v[48:49] op_sel:[1,1,0] op_sel_hi:[1,0,1] neg_lo:[1,0,0] neg_hi:[1,0,0]
  v_pk_fma_f32 v[86:87], v[56:57], v[84:85], v[50:51] op_sel:[1,1,0] op_sel_hi:[1,0,1] neg_lo:[1,0,0]
  v_pk_fma_f32 v[84:85], v[56:57], v[84:85], v[86:87] op_sel:[0,0,0] op_sel_hi:[0,1,1]
  v_pk_mul_f32 v[50:51], v[58:59], v[84:85] op_sel:[0,0] op_sel_hi:[0,1] neg_hi:[1,0]
  v_pk_fma_f32 v[50:51], v[58:59], v[84:85], v[50:51] op_sel:[1,1,0] op_sel_hi:[1,0,1] neg_lo:[1,0,0] neg_hi:[1,0,0]
  v_pk_fma_f32 v[86:87], v[56:57], v[84:85], v[52:53] op_sel:[1,1,0] op_sel_hi:[1,0,1] neg_lo:[1,0,0]
  v_pk_fma_f32 v[84:85], v[56:57], v[84:85], v[86:87] op_sel:[0,0,0] op_sel_hi:[0,1,1]
  v_pk_mul_f32 v[52:53], v[58:59], v[84:85] op_sel:[0,0] op_sel_hi:[0,1] neg_hi:[1,0]
  v_pk_fma_f32 v[52:53], v[58:59], v[84:85], v[52:53] op_sel:[1,1,0] op_sel_hi:[1,0,1] neg_lo:[1,0,0] neg_hi:[1,0,0]
  v_pk_fma_f32 v[86:87], v[56:57], v[84:85], v[54:55] op_sel:[1,1,0] op_sel_hi:[1,0,1] neg_lo:[1,0,0]
  v_pk_fma_f32 v[84:85], v[56:57], v[84:85], v[86:87] op_sel:[0,0,0] op_sel_hi:[0,1,1]
  v_pk_mul_f32 v[54:55], v[58:59], v[84:85] op_sel:[0,0] op_sel_hi:[0,1] neg_hi:[1,0]
  v_pk_fma_f32 v[54:55], v[58:59], v[84:85], v[54:55] op_sel:[1,1,0] op_sel_hi:[1,0,1] neg_lo:[1,0,0] neg_hi:[1,0,0]
  v_cvt_pk_bf16_f32 v128, v24, v26
  v_cvt_pk_bf16_f32 v136, v25, v27
  v_cvt_pk_bf16_f32 v129, v28, v30
  v_cvt_pk_bf16_f32 v137, v29, v31
  v_cvt_pk_bf16_f32 v130, v32, v34
  v_cvt_pk_bf16_f32 v138, v33, v35
  v_cvt_pk_bf16_f32 v131, v36, v38
  v_cvt_pk_bf16_f32 v139, v37, v39
  v_cvt_pk_bf16_f32 v132, v40, v42
  v_cvt_pk_bf16_f32 v140, v41, v43
  v_cvt_pk_bf16_f32 v133, v44, v46
  v_cvt_pk_bf16_f32 v141, v45, v47
  v_cvt_pk_bf16_f32 v134, v48, v50
  v_cvt_pk_bf16_f32 v142, v49, v51
  v_cvt_pk_bf16_f32 v135, v52, v54
  v_cvt_pk_bf16_f32 v143, v53, v55
  ds_write_b128 v210, v[128:131] offset:0
  ds_write_b128 v210, v[136:139] offset:2560
  ds_write_b128 v210, v[132:135] offset:16
  ds_write_b128 v210, v[140:143] offset:2576
  s_lshl_b32 s96, s29, 8
  s_lshl_b32 s97, s28, 2
  s_add_u32 s96, s96, s97
  s_add_u32 s96, s96, s31
  s_lshl_b32 s96, s96, 10
  s_add_u32 s96, s96, 8388608
  s_waitcnt lgkmcnt(0)
  ds_read_b64_tr_b16 v[96:97], v211 offset:0
  ds_read_b64_tr_b16 v[98:99], v211 offset:1280
  ds_read_b64_tr_b16 v[100:101], v211 offset:64
  ds_read_b64_tr_b16 v[102:103], v211 offset:1344
  ds_read_b64_tr_b16 v[104:105], v211 offset:128
  ds_read_b64_tr_b16 v[106:107], v211 offset:1408
  ds_read_b64_tr_b16 v[108:109], v211 offset:192
  ds_read_b64_tr_b16 v[110:111], v211 offset:1472
  s_waitcnt lgkmcnt(0)
  v_mov_b32 v172, 139264
  v_mov_b32 v173, 1
  s_mov_b64 exec, 1
  ds_add_u32 v172, v173
  s_mov_b64 exec, -1
  buffer_store_dwordx4 v[96:99], v1, s[4:7], s96 offen sc1
  s_add_u32 s96, s96, 65536
  buffer_store_dwordx4 v[100:103], v1, s[4:7], s96 offen sc1
  s_add_u32 s96, s96, 65536
  buffer_store_dwordx4 v[104:107], v1, s[4:7], s96 offen sc1
  s_add_u32 s96, s96, 65536
  buffer_store_dwordx4 v[108:111], v1, s[4:7], s96 offen sc1
  s_add_u32 s96, s96, 65536
  s_waitcnt vmcnt(0)
  s_lshl_b32 s96, s29, 4
  s_add_u32 s96, s96, s28
  s_lshl_b32 s96, s96, 2
  s_add_u32 s96, s96, s31
  s_lshl_b32 s96, s96, 7
  s_add_u32 s96, s96, 23134208
  s_mov_b64 exec, 1
  v_mov_b32 v172, s24
  v_mov_b32 v173, s25
  buffer_store_dwordx2 v[172:173], v213, s[4:7], s96 offen sc1
  s_mov_b64 exec, -1
  s_and_b32 s56, s2, 7
  s_lshl_b32 s56, s56, 2
  s_lshr_b32 s36, s2, 6
  s_add_u32 s56, s56, s36
  s_bfe_u32 s57, s2, 0x30003
  s_lshr_b32 s58, s56, 1
  s_and_b32 s36, s31, 1
  s_lshl_b32 s42, s56, 1
  s_add_u32 s42, s42, s36
  s_lshr_b32 s36, s31, 1
  s_lshl_b32 s43, s57, 1
  s_add_u32 s43, s43, s36
  v_lshlrev_b32 v168, 7, v0
  s_lshl_b32 s96, s57, 12
  s_add_u32 s96, s96, 22937600
  s_mov_b32 exec_lo, -1
  s_mov_b32 exec_hi, 0
  s_mov_b32 s26, 400000
L_poll_ph:
  buffer_load_dwordx2 v[170:171], v168, s[4:7], s96 offen sc1
  s_waitcnt vmcnt(0)
  v_cmp_ne_u32 vcc, s24, v170
  v_cmp_ne_u32 s[36:37], s25, v171
  s_or_b64 vcc, vcc, s[36:37]
  s_cbranch_vccz L_polld_ph
  s_sub_u32 s26, s26, 1
  s_cbranch_scc1 L_polld_ph
  s_sleep 4
  s_branch L_poll_ph
L_polld_ph:
  s_mov_b64 exec, -1
  v_mov_b32 v170, 139264
  s_mov_b32 s26, 400000
L_f_cnt_u:
  ds_read_b32 v171, v170
  s_waitcnt lgkmcnt(0)
  v_readfirstlane_b32 s36, v171
  s_nop 3
  s_cmp_ge_u32 s36, 4
  s_cbranch_scc1 L_f_cntd_u
  s_sub_u32 s26, s26, 1
  s_cbranch_scc1 L_f_cntd_u
  s_sleep 2
  s_branch L_f_cnt_u
L_f_cntd_u:
  s_lshl_b32 s45, s43, 5
  s_and_b32 s36, s31, 1
  s_lshl_b32 s36, s36, 3
  s_add_u32 s36, s36, s45
  s_lshl_b32 s36, s36, 10
  s_add_u32 s36, s36, 22151168
  s_lshl_b32 s37, s31, 13
  s_add_u32 m0, s37, 0
  s_nop 0
  buffer_load_dwordx4 v1, s[4:7], s36 offen offset:0 sc1 lds
  buffer_load_dwordx4 v1, s[4:7], s36 offen offset:1024 sc1 lds
  buffer_load_dwordx4 v1, s[4:7], s36 offen offset:2048 sc1 lds
  buffer_load_dwordx4 v1, s[4:7], s36 offen offset:3072 sc1 lds
  s_add_u32 s36, s36, 4096
  s_add_u32 m0, s37, 4096
  s_nop 0
  buffer_load_dwordx4 v1, s[4:7], s36 offen offset:0 sc1 lds
  buffer_load_dwordx4 v1, s[4:7], s36 offen offset:1024 sc1 lds
  buffer_load_dwordx4 v1, s[4:7], s36 offen offset:2048 sc1 lds
  buffer_load_dwordx4 v1, s[4:7], s36 offen offset:3072 sc1 lds
  s_add_u32 s36, s36, 4096
  s_add_u32 s45, s45, 16
  s_lshl_b32 s45, s45, 10
  s_add_u32 s45, s45, 22151168
  s_waitcnt vmcnt(0)
  buffer_load_dwordx4 v[136:139], v1, s[4:7], s45 offen offset:0 sc1
  buffer_load_dwordx4 v[140:143], v1, s[4:7], s45 offen offset:1024 sc1
  buffer_load_dwordx4 v[144:147], v1, s[4:7], s45 offen offset:2048 sc1
  buffer_load_dwordx4 v[148:151], v1, s[4:7], s45 offen offset:3072 sc1
  s_add_u32 s45, s45, 4096
  buffer_load_dwordx4 v[152:155], v1, s[4:7], s45 offen offset:0 sc1
  buffer_load_dwordx4 v[156:159], v1, s[4:7], s45 offen offset:1024 sc1
  buffer_load_dwordx4 v[160:163], v1, s[4:7], s45 offen offset:2048 sc1
  buffer_load_dwordx4 v[164:167], v1, s[4:7], s45 offen offset:3072 sc1
  s_waitcnt vmcnt(0)
  s_add_u32 s45, s45, 4096
  buffer_load_dwordx4 v[220:223], v1, s[4:7], s45 offen offset:0 sc1
  buffer_load_dwordx4 v[224:227], v1, s[4:7], s45 offen offset:1024 sc1
  buffer_load_dwordx4 v[228:231], v1, s[4:7], s45 offen offset:2048 sc1
  buffer_load_dwordx4 v[232:235], v1, s[4:7], s45 offen offset:3072 sc1
  s_add_u32 s45, s45, 4096
  buffer_load_dwordx4 v[236:239], v1, s[4:7], s45 offen offset:0 sc1
  buffer_load_dwordx4 v[240:243], v1, s[4:7], s45 offen offset:1024 sc1
  buffer_load_dwordx4 v[244:247], v1, s[4:7], s45 offen offset:2048 sc1
  buffer_load_dwordx4 v[248:251], v1, s[4:7], s45 offen offset:3072 sc1
  v_and_b32 v168, 31, v0
  s_lshl_b32 s36, s43, 5
  v_add_u32 v168, s36, v168
  v_lshlrev_b32 v169, 1, v168
  v_lshrrev_b32 v171, 5, v0
  v_lshl_add_u32 v172, v171, 14, v169
  s_lshl_b32 s36, s42, 15
  s_waitcnt vmcnt(0)
  buffer_load_short_d16_hi v183, v169, s[72:75], 0 offen
  s_add_u32 s37, s36, 0
  buffer_load_short_d16_hi v8, v172, s[8:11], s37 offen
  s_add_u32 s37, s36, 1024
  buffer_load_short_d16_hi v9, v172, s[8:11], s37 offen
  s_add_u32 s37, s36, 2048
  buffer_load_short_d16_hi v10, v172, s[8:11], s37 offen
  s_add_u32 s37, s36, 3072
  buffer_load_short_d16_hi v11, v172, s[8:11], s37 offen
  s_add_u32 s37, s36, 4096
  buffer_load_short_d16_hi v12, v172, s[8:11], s37 offen
  s_add_u32 s37, s36, 5120
  buffer_load_short_d16_hi v13, v172, s[8:11], s37 offen
  s_add_u32 s37, s36, 6144
  buffer_load_short_d16_hi v14, v172, s[8:11], s37 offen
  s_add_u32 s37, s36, 7168
  buffer_load_short_d16_hi v15, v172, s[8:11], s37 offen
  s_add_u32 s37, s36, 8192
  buffer_load_short_d16_hi v16, v172, s[8:11], s37 offen
  s_add_u32 s37, s36, 9216
  buffer_load_short_d16_hi v17, v172, s[8:11], s37 offen
  s_add_u32 s37, s36, 10240
  buffer_load_short_d16_hi v18, v172, s[8:11], s37 offen
  s_add_u32 s37, s36, 11264
  buffer_load_short_d16_hi v19, v172, s[8:11], s37 offen
  s_add_u32 s37, s36, 12288
  buffer_load_short_d16_hi v20, v172, s[8:11], s37 offen
  s_add_u32 s37, s36, 13312
  buffer_load_short_d16_hi v21, v172, s[8:11], s37 offen
  s_add_u32 s37, s36, 14336
  buffer_load_short_d16_hi v22, v172, s[8:11], s37 offen
  s_add_u32 s37, s36, 15360
  buffer_load_short_d16_hi v23, v172, s[8:11], s37 offen
  v_lshlrev_b32 v173, 6, v171
  v_lshlrev_b32 v168, 7, v0
  s_lshl_b32 s96, s58, 13
  s_add_u32 s96, s96, 23134208
  s_mov_b32 exec_lo, -1
  s_mov_b32 exec_hi, -1
  s_mov_b32 s26, 400000
L_poll_h:
  buffer_load_dwordx2 v[170:171], v168, s[4:7], s96 offen sc1
  s_waitcnt vmcnt(0)
  v_cmp_ne_u32 vcc, s24, v170
  v_cmp_ne_u32 s[36:37], s25, v171
  s_or_b64 vcc, vcc, s[36:37]
  s_cbranch_vccz L_polld_h
  s_sub_u32 s26, s26, 1
  s_cbranch_scc1 L_polld_h
  s_sleep 8
  s_branch L_poll_h
L_polld_h:
  s_mov_b64 exec, -1
  s_lshl_b32 s36, s42, 7
  s_add_u32 s36, s36, 21037056
  buffer_load_dwordx4 v[184:187], v173, s[4:7], s36 offen offset:0 sc1
  buffer_load_dwordx4 v[188:191], v173, s[4:7], s36 offen offset:16 sc1
  buffer_load_dwordx4 v[192:195], v173, s[4:7], s36 offen offset:32 sc1
  buffer_load_dwordx4 v[196:199], v173, s[4:7], s36 offen offset:48 sc1
  s_lshl_b32 s44, s56, 7
  s_lshl_b32 s36, s31, 4
  s_add_u32 s44, s44, s36
  s_lshl_b32 s44, s44, 10
  s_add_u32 s44, s44, 8388608
  s_add_u32 s46, s44, 65536
  s_lshl_b32 s45, s57, 7
  s_add_u32 s45, s45, s36
  s_lshl_b32 s45, s45, 10
  s_add_u32 s45, s45, 21102592
  s_add_u32 s47, s45, 65536
  s_setprio 0
  buffer_load_dwordx4 v[104:107], v1, s[4:7], s44 offen offset:0 sc1
  buffer_load_dwordx4 v[108:111], v1, s[4:7], s46 offen offset:0 sc1
  buffer_load_dwordx4 v[112:115], v1, s[4:7], s45 offen offset:0 sc1
  buffer_load_dwordx4 v[116:119], v1, s[4:7], s47 offen offset:0 sc1
  buffer_load_dwordx4 v[120:123], v1, s[4:7], s44 offen offset:1024 sc1
  buffer_load_dwordx4 v[124:127], v1, s[4:7], s46 offen offset:1024 sc1
  buffer_load_dwordx4 v[128:131], v1, s[4:7], s45 offen offset:1024 sc1
  buffer_load_dwordx4 v[132:135], v1, s[4:7], s47 offen offset:1024 sc1
  s_waitcnt vmcnt(4)
  v_mfma_f32_32x32x16_bf16 v[40:55], v[104:107], v[112:115], 0
  v_mfma_f32_32x32x16_bf16 v[56:71], v[108:111], v[112:115], 0
  v_mfma_f32_32x32x16_bf16 v[72:87], v[104:107], v[116:119], 0
  v_mfma_f32_32x32x16_bf16 v[88:103], v[108:111], v[116:119], 0
  buffer_load_dwordx4 v[104:107], v1, s[4:7], s44 offen offset:2048 sc1
  buffer_load_dwordx4 v[108:111], v1, s[4:7], s46 offen offset:2048 sc1
  buffer_load_dwordx4 v[112:115], v1, s[4:7], s45 offen offset:2048 sc1
  buffer_load_dwordx4 v[116:119], v1, s[4:7], s47 offen offset:2048 sc1
  s_waitcnt vmcnt(4)
  v_mfma_f32_32x32x16_bf16 v[40:55], v[120:123], v[128:131], v[40:55]
  v_mfma_f32_32x32x16_bf16 v[56:71], v[124:127], v[128:131], v[56:71]
  v_mfma_f32_32x32x16_bf16 v[72:87], v[120:123], v[132:135], v[72:87]
  v_mfma_f32_32x32x16_bf16 v[88:103], v[124:127], v[132:135], v[88:103]
  buffer_load_dwordx4 v[120:123], v1, s[4:7], s44 offen offset:3072 sc1
  buffer_load_dwordx4 v[124:127], v1, s[4:7], s46 offen offset:3072 sc1
  buffer_load_dwordx4 v[128:131], v1, s[4:7], s45 offen offset:3072 sc1
  buffer_load_dwordx4 v[132:135], v1, s[4:7], s47 offen offset:3072 sc1
  s_add_u32 s44, s44, 4096
  s_add_u32 s46, s46, 4096
  s_add_u32 s45, s45, 4096
  s_add_u32 s47, s47, 4096
  s_waitcnt vmcnt(4)
  v_mfma_f32_32x32x16_bf16 v[40:55], v[104:107], v[112:115], v[40:55]
  v_mfma_f32_32x32x16_bf16 v[56:71], v[108:111], v[112:115], v[56:71]
  v_mfma_f32_32x32x16_bf16 v[72:87], v[104:107], v[116:119], v[72:87]
  v_mfma_f32_32x32x16_bf16 v[88:103], v[108:111], v[116:119], v[88:103]
  buffer_load_dwordx4 v[104:107], v1, s[4:7], s44 offen offset:0 sc1
  buffer_load_dwordx4 v[108:111], v1, s[4:7], s46 offen offset:0 sc1
  buffer_load_dwordx4 v[112:115], v1, s[4:7], s45 offen offset:0 sc1
  buffer_load_dwordx4 v[116:119], v1, s[4:7], s47 offen offset:0 sc1
  s_waitcnt vmcnt(4)
  v_mfma_f32_32x32x16_bf16 v[40:55], v[120:123], v[128:131], v[40:55]
  v_mfma_f32_32x32x16_bf16 v[56:71], v[124:127], v[128:131], v[56:71]
  v_mfma_f32_32x32x16_bf16 v[72:87], v[120:123], v[132:135], v[72:87]
  v_mfma_f32_32x32x16_bf16 v[88:103], v[124:127], v[132:135], v[88:103]
  buffer_load_dwordx4 v[120:123], v1, s[4:7], s44 offen offset:1024 sc1
  buffer_load_dwordx4 v[124:127], v1, s[4:7], s46 offen offset:1024 sc1
  buffer_load_dwordx4 v[128:131], v1, s[4:7], s45 offen offset:1024 sc1
  buffer_load_dwordx4 v[132:135], v1, s[4:7], s47 offen offset:1024 sc1
  s_waitcnt vmcnt(4)
  v_mfma_f32_32x32x16_bf16 v[40:55], v[104:107], v[112:115], v[40:55]
  v_mfma_f32_32x32x16_bf16 v[56:71], v[108:111], v[112:115], v[56:71]
  v_mfma_f32_32x32x16_bf16 v[72:87], v[104:107], v[116:119], v[72:87]
  v_mfma_f32_32x32x16_bf16 v[88:103], v[108:111], v[116:119], v[88:103]
  buffer_load_dwordx4 v[104:107], v1, s[4:7], s44 offen offset:2048 sc1
  buffer_load_dwordx4 v[108:111], v1, s[4:7], s46 offen offset:2048 sc1
  buffer_load_dwordx4 v[112:115], v1, s[4:7], s45 offen offset:2048 sc1
  buffer_load_dwordx4 v[116:119], v1, s[4:7], s47 offen offset:2048 sc1
  s_waitcnt vmcnt(4)
  v_mfma_f32_32x32x16_bf16 v[40:55], v[120:123], v[128:131], v[40:55]
  v_mfma_f32_32x32x16_bf16 v[56:71], v[124:127], v[128:131], v[56:71]
  v_mfma_f32_32x32x16_bf16 v[72:87], v[120:123], v[132:135], v[72:87]
  v_mfma_f32_32x32x16_bf16 v[88:103], v[124:127], v[132:135], v[88:103]
  buffer_load_dwordx4 v[120:123], v1, s[4:7], s44 offen offset:3072 sc1
  buffer_load_dwordx4 v[124:127], v1, s[4:7], s46 offen offset:3072 sc1
  buffer_load_dwordx4 v[128:131], v1, s[4:7], s45 offen offset:3072 sc1
  buffer_load_dwordx4 v[132:135], v1, s[4:7], s47 offen offset:3072 sc1
  s_add_u32 s44, s44, 4096
  s_add_u32 s46, s46, 4096
  s_add_u32 s45, s45, 4096
  s_add_u32 s47, s47, 4096
  s_waitcnt vmcnt(4)
  v_mfma_f32_32x32x16_bf16 v[40:55], v[104:107], v[112:115], v[40:55]
  v_mfma_f32_32x32x16_bf16 v[56:71], v[108:111], v[112:115], v[56:71]
  v_mfma_f32_32x32x16_bf16 v[72:87], v[104:107], v[116:119], v[72:87]
  v_mfma_f32_32x32x16_bf16 v[88:103], v[108:111], v[116:119], v[88:103]
  buffer_load_dwordx4 v[104:107], v1, s[4:7], s44 offen offset:0 sc1
  buffer_load_dwordx4 v[108:111], v1, s[4:7], s46 offen offset:0 sc1
  buffer_load_dwordx4 v[112:115], v1, s[4:7], s45 offen offset:0 sc1
  buffer_load_dwordx4 v[116:119], v1, s[4:7], s47 offen offset:0 sc1
  s_waitcnt vmcnt(4)
  v_mfma_f32_32x32x16_bf16 v[40:55], v[120:123], v[128:131], v[40:55]
  v_mfma_f32_32x32x16_bf16 v[56:71], v[124:127], v[128:131], v[56:71]
  v_mfma_f32_32x32x16_bf16 v[72:87], v[120:123], v[132:135], v[72:87]
  v_mfma_f32_32x32x16_bf16 v[88:103], v[124:127], v[132:135], v[88:103]
  buffer_load_dwordx4 v[120:123], v1, s[4:7], s44 offen offset:1024 sc1
  buffer_load_dwordx4 v[124:127], v1, s[4:7], s46 offen offset:1024 sc1
  buffer_load_dwordx4 v[128:131], v1, s[4:7], s45 offen offset:1024 sc1
  buffer_load_dwordx4 v[132:135], v1, s[4:7], s47 offen offset:1024 sc1
  s_waitcnt vmcnt(4)
  v_mfma_f32_32x32x16_bf16 v[40:55], v[104:107], v[112:115], v[40:55]
  v_mfma_f32_32x32x16_bf16 v[56:71], v[108:111], v[112:115], v[56:71]
  v_mfma_f32_32x32x16_bf16 v[72:87], v[104:107], v[116:119], v[72:87]
  v_mfma_f32_32x32x16_bf16 v[88:103], v[108:111], v[116:119], v[88:103]
  buffer_load_dwordx4 v[104:107], v1, s[4:7], s44 offen offset:2048 sc1
  buffer_load_dwordx4 v[108:111], v1, s[4:7], s46 offen offset:2048 sc1
  buffer_load_dwordx4 v[112:115], v1, s[4:7], s45 offen offset:2048 sc1
  buffer_load_dwordx4 v[116:119], v1, s[4:7], s47 offen offset:2048 sc1
  s_waitcnt vmcnt(4)
  v_mfma_f32_32x32x16_bf16 v[40:55], v[120:123], v[128:131], v[40:55]
  v_mfma_f32_32x32x16_bf16 v[56:71], v[124:127], v[128:131], v[56:71]
  v_mfma_f32_32x32x16_bf16 v[72:87], v[120:123], v[132:135], v[72:87]
  v_mfma_f32_32x32x16_bf16 v[88:103], v[124:127], v[132:135], v[88:103]
  buffer_load_dwordx4 v[120:123], v1, s[4:7], s44 offen offset:3072 sc1
  buffer_load_dwordx4 v[124:127], v1, s[4:7], s46 offen offset:3072 sc1
  buffer_load_dwordx4 v[128:131], v1, s[4:7], s45 offen offset:3072 sc1
  buffer_load_dwordx4 v[132:135], v1, s[4:7], s47 offen offset:3072 sc1
  s_add_u32 s44, s44, 4096
  s_add_u32 s46, s46, 4096
  s_add_u32 s45, s45, 4096
  s_add_u32 s47, s47, 4096
  s_waitcnt vmcnt(4)
  v_mfma_f32_32x32x16_bf16 v[40:55], v[104:107], v[112:115], v[40:55]
  v_mfma_f32_32x32x16_bf16 v[56:71], v[108:111], v[112:115], v[56:71]
  v_mfma_f32_32x32x16_bf16 v[72:87], v[104:107], v[116:119], v[72:87]
  v_mfma_f32_32x32x16_bf16 v[88:103], v[108:111], v[116:119], v[88:103]
  buffer_load_dwordx4 v[104:107], v1, s[4:7], s44 offen offset:0 sc1
  buffer_load_dwordx4 v[108:111], v1, s[4:7], s46 offen offset:0 sc1
  buffer_load_dwordx4 v[112:115], v1, s[4:7], s45 offen offset:0 sc1
  buffer_load_dwordx4 v[116:119], v1, s[4:7], s47 offen offset:0 sc1
  s_waitcnt vmcnt(4)
  v_mfma_f32_32x32x16_bf16 v[40:55], v[120:123], v[128:131], v[40:55]
  v_mfma_f32_32x32x16_bf16 v[56:71], v[124:127], v[128:131], v[56:71]
  v_mfma_f32_32x32x16_bf16 v[72:87], v[120:123], v[132:135], v[72:87]
  v_mfma_f32_32x32x16_bf16 v[88:103], v[124:127], v[132:135], v[88:103]
  buffer_load_dwordx4 v[120:123], v1, s[4:7], s44 offen offset:1024 sc1
  buffer_load_dwordx4 v[124:127], v1, s[4:7], s46 offen offset:1024 sc1
  buffer_load_dwordx4 v[128:131], v1, s[4:7], s45 offen offset:1024 sc1
  buffer_load_dwordx4 v[132:135], v1, s[4:7], s47 offen offset:1024 sc1
  s_waitcnt vmcnt(4)
  v_mfma_f32_32x32x16_bf16 v[40:55], v[104:107], v[112:115], v[40:55]
  v_mfma_f32_32x32x16_bf16 v[56:71], v[108:111], v[112:115], v[56:71]
  v_mfma_f32_32x32x16_bf16 v[72:87], v[104:107], v[116:119], v[72:87]
  v_mfma_f32_32x32x16_bf16 v[88:103], v[108:111], v[116:119], v[88:103]
  buffer_load_dwordx4 v[104:107], v1, s[4:7], s44 offen offset:2048 sc1
  buffer_load_dwordx4 v[108:111], v1, s[4:7], s46 offen offset:2048 sc1
  buffer_load_dwordx4 v[112:115], v1, s[4:7], s45 offen offset:2048 sc1
  buffer_load_dwordx4 v[116:119], v1, s[4:7], s47 offen offset:2048 sc1
  s_waitcnt vmcnt(4)
  v_mfma_f32_32x32x16_bf16 v[40:55], v[120:123], v[128:131], v[40:55]
  v_mfma_f32_32x32x16_bf16 v[56:71], v[124:127], v[128:131], v[56:71]
  v_mfma_f32_32x32x16_bf16 v[72:87], v[120:123], v[132:135], v[72:87]
  v_mfma_f32_32x32x16_bf16 v[88:103], v[124:127], v[132:135], v[88:103]
  buffer_load_dwordx4 v[120:123], v1, s[4:7], s44 offen offset:3072 sc1
  buffer_load_dwordx4 v[124:127], v1, s[4:7], s46 offen offset:3072 sc1
  buffer_load_dwordx4 v[128:131], v1, s[4:7], s45 offen offset:3072 sc1
  buffer_load_dwordx4 v[132:135], v1, s[4:7], s47 offen offset:3072 sc1
  s_add_u32 s44, s44, 4096
  s_add_u32 s46, s46, 4096
  s_add_u32 s45, s45, 4096
  s_add_u32 s47, s47, 4096
  s_waitcnt vmcnt(4)
  v_mfma_f32_32x32x16_bf16 v[40:55], v[104:107], v[112:115], v[40:55]
  v_mfma_f32_32x32x16_bf16 v[56:71], v[108:111], v[112:115], v[56:71]
  v_mfma_f32_32x32x16_bf16 v[72:87], v[104:107], v[116:119], v[72:87]
  v_mfma_f32_32x32x16_bf16 v[88:103], v[108:111], v[116:119], v[88:103]
  s_waitcnt vmcnt(0)
  v_mfma_f32_32x32x16_bf16 v[40:55], v[120:123], v[128:131], v[40:55]
  v_mfma_f32_32x32x16_bf16 v[56:71], v[124:127], v[128:131], v[56:71]
  v_mfma_f32_32x32x16_bf16 v[72:87], v[120:123], v[132:135], v[72:87]
  v_mfma_f32_32x32x16_bf16 v[88:103], v[124:127], v[132:135], v[88:103]
  s_nop 15
  s_setprio 1
  v_mov_b32 v170, 139264
  s_mov_b32 s26, 400000
L_f_cnt_h:
  ds_read_b32 v171, v170
  s_waitcnt lgkmcnt(0)
  v_readfirstlane_b32 s36, v171
  s_nop 3
  s_cmp_ge_u32 s36, 8
  s_cbranch_scc1 L_f_cntd_h
  s_sub_u32 s26, s26, 1
  s_cbranch_scc1 L_f_cntd_h
  s_sleep 2
  s_branch L_f_cnt_h
L_f_cntd_h:
  s_cmp_eq_u32 s31, 0
  s_cbranch_scc0 L_f_ysend0
  v_add_u32 v168, 45056, v1
  ds_write_b128 v168, v[56:59] offset:0
  ds_write_b128 v168, v[60:63] offset:1024
  ds_write_b128 v168, v[64:67] offset:2048
  ds_write_b128 v168, v[68:71] offset:3072
  v_add_u32 v168, 61440, v1
  ds_write_b128 v168, v[72:75] offset:0
  ds_write_b128 v168, v[76:79] offset:1024
  ds_write_b128 v168, v[80:83] offset:2048
  ds_write_b128 v168, v[84:87] offset:3072
  v_add_u32 v168, 77824, v1
  ds_write_b128 v168, v[88:91] offset:0
  ds_write_b128 v168, v[92:95] offset:1024
  ds_write_b128 v168, v[96:99] offset:2048
  ds_write_b128 v168, v[100:103] offset:3072
  v_fma_f32 v8, v8, v183, v40
  v_fma_f32 v9, v9, v183, v41
  v_fma_f32 v10, v10, v183, v42
  v_fma_f32 v11, v11, v183, v43
  v_fma_f32 v12, v12, v183, v44
  v_fma_f32 v13, v13, v183, v45
  v_fma_f32 v14, v14, v183, v46
  v_fma_f32 v15, v15, v183, v47
  v_fma_f32 v16, v16, v183, v48
  v_fma_f32 v17, v17, v183, v49
  v_fma_f32 v18, v18, v183, v50
  v_fma_f32 v19, v19, v183, v51
  v_fma_f32 v20, v20, v183, v52
  v_fma_f32 v21, v21, v183, v53
  v_fma_f32 v22, v22, v183, v54
  v_fma_f32 v23, v23, v183, v55
  s_waitcnt lgkmcnt(0)
L_f_ysend0:
  s_cmp_eq_u32 s31, 1
  s_cbranch_scc0 L_f_ysend1
  v_add_u32 v168, 57344, v1
  ds_write_b128 v168, v[72:75] offset:0
  ds_write_b128 v168, v[76:79] offset:1024
  ds_write_b128 v168, v[80:83] offset:2048
  ds_write_b128 v168, v[84:87] offset:3072
  v_add_u32 v168, 73728, v1
  ds_write_b128 v168, v[88:91] offset:0
  ds_write_b128 v168, v[92:95] offset:1024
  ds_write_b128 v168, v[96:99] offset:2048
  ds_write_b128 v168, v[100:103] offset:3072
  v_add_u32 v168, 40960, v1
  ds_write_b128 v168, v[40:43] offset:0
  ds_write_b128 v168, v[44:47] offset:1024
  ds_write_b128 v168, v[48:51] offset:2048
  ds_write_b128 v168, v[52:55] offset:3072
  v_fma_f32 v8, v8, v183, v56
  v_fma_f32 v9, v9, v183, v57
  v_fma_f32 v10, v10, v183, v58
  v_fma_f32 v11, v11, v183, v59
  v_fma_f32 v12, v12, v183, v60
  v_fma_f32 v13, v13, v183, v61
  v_fma_f32 v14, v14, v183, v62
  v_fma_f32 v15, v15, v183, v63
  v_fma_f32 v16, v16, v183, v64
  v_fma_f32 v17, v17, v183, v65
  v_fma_f32 v18, v18, v183, v66
  v_fma_f32 v19, v19, v183, v67
  v_fma_f32 v20, v20, v183, v68
  v_fma_f32 v21, v21, v183, v69
  v_fma_f32 v22, v22, v183, v70
  v_fma_f32 v23, v23, v183, v71
  s_waitcnt lgkmcnt(0)
L_f_ysend1:
  s_cmp_eq_u32 s31, 2
  s_cbranch_scc0 L_f_ysend2
  v_add_u32 v168, 69632, v1
  ds_write_b128 v168, v[88:91] offset:0
  ds_write_b128 v168, v[92:95] offset:1024
  ds_write_b128 v168, v[96:99] offset:2048
  ds_write_b128 v168, v[100:103] offset:3072
  v_add_u32 v168, 36864, v1
  ds_write_b128 v168, v[40:43] offset:0
  ds_write_b128 v168, v[44:47] offset:1024
  ds_write_b128 v168, v[48:51] offset:2048
  ds_write_b128 v168, v[52:55] offset:3072
  v_add_u32 v168, 53248, v1
  ds_write_b128 v168, v[56:59] offset:0
  ds_write_b128 v168, v[60:63] offset:1024
  ds_write_b128 v168, v[64:67] offset:2048
  ds_write_b128 v168, v[68:71] offset:3072
  v_fma_f32 v8, v8, v183, v72
  v_fma_f32 v9, v9, v183, v73
  v_fma_f32 v10, v10, v183, v74
  v_fma_f32 v11, v11, v183, v75
  v_fma_f32 v12, v12, v183, v76
  v_fma_f32 v13, v13, v183, v77
  v_fma_f32 v14, v14, v183, v78
  v_fma_f32 v15, v15, v183, v79
  v_fma_f32 v16, v16, v183, v80
  v_fma_f32 v17, v17, v183, v81
  v_fma_f32 v18, v18, v183, v82
  v_fma_f32 v19, v19, v183, v83
  v_fma_f32 v20, v20, v183, v84
  v_fma_f32 v21, v21, v183, v85
  v_fma_f32 v22, v22, v183, v86
  v_fma_f32 v23, v23, v183, v87
  s_waitcnt lgkmcnt(0)
L_f_ysend2:
  s_cmp_eq_u32 s31, 3
  s_cbranch_scc0 L_f_ysend3
  v_add_u32 v168, 32768, v1
  ds_write_b128 v168, v[40:43] offset:0
  ds_write_b128 v168, v[44:47] offset:1024
  ds_write_b128 v168, v[48:51] offset:2048
  ds_write_b128 v168, v[52:55] offset:3072
  v_add_u32 v168, 49152, v1
  ds_write_b128 v168, v[56:59] offset:0
  ds_write_b128 v168, v[60:63] offset:1024
  ds_write_b128 v168, v[64:67] offset:2048
  ds_write_b128 v168, v[68:71] offset:3072
  v_add_u32 v168, 65536, v1
  ds_write_b128 v168, v[72:75] offset:0
  ds_write_b128 v168, v[76:79] offset:1024
  ds_write_b128 v168, v[80:83] offset:2048
  ds_write_b128 v168, v[84:87] offset:3072
  v_fma_f32 v8, v8, v183, v88
  v_fma_f32 v9, v9, v183, v89
  v_fma_f32 v10, v10, v183, v90
  v_fma_f32 v11, v11, v183, v91
  v_fma_f32 v12, v12, v183, v92
  v_fma_f32 v13, v13, v183, v93
  v_fma_f32 v14, v14, v183, v94
  v_fma_f32 v15, v15, v183, v95
  v_fma_f32 v16, v16, v183, v96
  v_fma_f32 v17, v17, v183, v97
  v_fma_f32 v18, v18, v183, v98
  v_fma_f32 v19, v19, v183, v99
  v_fma_f32 v20, v20, v183, v100
  v_fma_f32 v21, v21, v183, v101
  v_fma_f32 v22, v22, v183, v102
  v_fma_f32 v23, v23, v183, v103
  s_waitcnt lgkmcnt(0)
L_f_ysend3:
  s_barrier
  s_mul_i32 s36, s31, 12288
  s_add_u32 s36, s36, 32768
  v_add_u32 v174, s36, v1
  ds_read_b128 v[40:43], v174 offset:0
  ds_read_b128 v[44:47], v174 offset:1024
  ds_read_b128 v[48:51], v174 offset:2048
  ds_read_b128 v[52:55], v174 offset:3072
  ds_read_b128 v[56:59], v174 offset:4096
  ds_read_b128 v[60:63], v174 offset:5120
  ds_read_b128 v[64:67], v174 offset:6144
  ds_read_b128 v[68:71], v174 offset:7168
  ds_read_b128 v[72:75], v174 offset:8192
  ds_read_b128 v[76:79], v174 offset:9216
  ds_read_b128 v[80:83], v174 offset:10240
  ds_read_b128 v[84:87], v174 offset:11264
  s_waitcnt lgkmcnt(0)
  v_add_f32 v8, v8, v40
  v_add_f32 v9, v9, v41
  v_add_f32 v10, v10, v42
  v_add_f32 v11, v11, v43
  v_add_f32 v12, v12, v44
  v_add_f32 v13, v13, v45
  v_add_f32 v14, v14, v46
  v_add_f32 v15, v15, v47
  v_add_f32 v16, v16, v48
  v_add_f32 v17, v17, v49
  v_add_f32 v18, v18, v50
  v_add_f32 v19, v19, v51
  v_add_f32 v20, v20, v52
  v_add_f32 v21, v21, v53
  v_add_f32 v22, v22, v54
  v_add_f32 v23, v23, v55
  v_add_f32 v8, v8, v56
  v_add_f32 v9, v9, v57
  v_add_f32 v10, v10, v58
  v_add_f32 v11, v11, v59
  v_add_f32 v12, v12, v60
  v_add_f32 v13, v13, v61
  v_add_f32 v14, v14, v62
  v_add_f32 v15, v15, v63
  v_add_f32 v16, v16, v64
  v_add_f32 v17, v17, v65
  v_add_f32 v18, v18, v66
  v_add_f32 v19, v19, v67
  v_add_f32 v20, v20, v68
  v_add_f32 v21, v21, v69
  v_add_f32 v22, v22, v70
  v_add_f32 v23, v23, v71
  v_add_f32 v8, v8, v72
  v_add_f32 v9, v9, v73
  v_add_f32 v10, v10, v74
  v_add_f32 v11, v11, v75
  v_add_f32 v12, v12, v76
  v_add_f32 v13, v13, v77
  v_add_f32 v14, v14, v78
  v_add_f32 v15, v15, v79
  v_add_f32 v16, v16, v80
  v_add_f32 v17, v17, v81
  v_add_f32 v18, v18, v82
  v_add_f32 v19, v19, v83
  v_add_f32 v20, v20, v84
  v_add_f32 v21, v21, v85
  v_add_f32 v22, v22, v86
  v_add_f32 v23, v23, v87
  v_lshlrev_b32 v168, 7, v0
  s_lshl_b32 s44, s42, 5
  s_add_u32 s44, s44, 16
  s_lshl_b32 s44, s44, 10
  s_add_u32 s44, s44, 6291456
  s_mov_b32 s26, 400000
  v_lshlrev_b32 v168, 10, v0
  v_add_u32 v168, 896, v168
L_osent_h:
  s_mov_b32 exec_lo, 0xffff
  s_mov_b32 exec_hi, 0
  buffer_load_dword v170, v168, s[4:7], s44 offen sc1
  s_waitcnt vmcnt(0)
  v_cmp_eq_u32 vcc, -1, v170
  s_mov_b64 exec, -1
  s_cbranch_vccz L_osent_go_h
  s_sub_u32 s26, s26, 1
  s_cbranch_scc1 L_osent_go_h
  s_sleep 1
  s_branch L_osent_h
L_osent_go_h:
  s_mov_b32 s97, s44
  buffer_load_dwordx4 v[40:43], v1, s[4:7], s97 offen offset:0 sc1
  buffer_load_dwordx4 v[44:47], v1, s[4:7], s97 offen offset:1024 sc1
  buffer_load_dwordx4 v[48:51], v1, s[4:7], s97 offen offset:2048 sc1
  buffer_load_dwordx4 v[52:55], v1, s[4:7], s97 offen offset:3072 sc1
  s_add_u32 s97, s97, 4096
  buffer_load_dwordx4 v[56:59], v1, s[4:7], s97 offen offset:0 sc1
  buffer_load_dwordx4 v[60:63], v1, s[4:7], s97 offen offset:1024 sc1
  buffer_load_dwordx4 v[64:67], v1, s[4:7], s97 offen offset:2048 sc1
  buffer_load_dwordx4 v[68:71], v1, s[4:7], s97 offen offset:3072 sc1
  s_add_u32 s97, s97, 4096
  buffer_load_dwordx4 v[72:75], v1, s[4:7], s97 offen offset:0 sc1
  buffer_load_dwordx4 v[76:79], v1, s[4:7], s97 offen offset:1024 sc1
  buffer_load_dwordx4 v[80:83], v1, s[4:7], s97 offen offset:2048 sc1
  buffer_load_dwordx4 v[84:87], v1, s[4:7], s97 offen offset:3072 sc1
  s_add_u32 s97, s97, 4096
  buffer_load_dwordx4 v[88:91], v1, s[4:7], s97 offen offset:0 sc1
  buffer_load_dwordx4 v[92:95], v1, s[4:7], s97 offen offset:1024 sc1
  buffer_load_dwordx4 v[96:99], v1, s[4:7], s97 offen offset:2048 sc1
  buffer_load_dwordx4 v[100:103], v1, s[4:7], s97 offen offset:3072 sc1
  v_mov_b32 v170, 0
  s_waitcnt vmcnt(15) lgkmcnt(0)
  v_mfma_f32_32x32x16_bf16 v[24:39], v[40:43], v[136:139], 0
  v_max3_u32 v170, v170, v40, v41
  v_max3_u32 v170, v170, v42, v43
  s_waitcnt vmcnt(14)
  v_mfma_f32_32x32x16_bf16 v[24:39], v[44:47], v[140:143], v[24:39]
  v_max3_u32 v170, v170, v44, v45
  v_max3_u32 v170, v170, v46, v47
  s_waitcnt vmcnt(13)
  v_mfma_f32_32x32x16_bf16 v[24:39], v[48:51], v[144:147], v[24:39]
  v_max3_u32 v170, v170, v48, v49
  v_max3_u32 v170, v170, v50, v51
  s_waitcnt vmcnt(12)
  v_mfma_f32_32x32x16_bf16 v[24:39], v[52:55], v[148:151], v[24:39]
  v_max3_u32 v170, v170, v52, v53
  v_max3_u32 v170, v170, v54, v55
  s_waitcnt vmcnt(11)
  v_mfma_f32_32x32x16_bf16 v[24:39], v[56:59], v[152:155], v[24:39]
  v_max3_u32 v170, v170, v56, v57
  v_max3_u32 v170, v170, v58, v59
  s_waitcnt vmcnt(10)
  v_mfma_f32_32x32x16_bf16 v[24:39], v[60:63], v[156:159], v[24:39]
  v_max3_u32 v170, v170, v60, v61
  v_max3_u32 v170, v170, v62, v63
  s_waitcnt vmcnt(9)
  v_mfma_f32_32x32x16_bf16 v[24:39], v[64:67], v[160:163], v[24:39]
  v_max3_u32 v170, v170, v64, v65
  v_max3_u32 v170, v170, v66, v67
  s_waitcnt vmcnt(8)
  v_mfma_f32_32x32x16_bf16 v[24:39], v[68:71], v[164:167], v[24:39]
  v_max3_u32 v170, v170, v68, v69
  v_max3_u32 v170, v170, v70, v71
  s_waitcnt vmcnt(7)
  v_mfma_f32_32x32x16_bf16 v[24:39], v[72:75], v[220:223], v[24:39]
  v_max3_u32 v170, v170, v72, v73
  v_max3_u32 v170, v170, v74, v75
  s_waitcnt vmcnt(6)
  v_mfma_f32_32x32x16_bf16 v[24:39], v[76:79], v[224:227], v[24:39]
  v_max3_u32 v170, v170, v76, v77
  v_max3_u32 v170, v170, v78, v79
  s_waitcnt vmcnt(5)
  v_mfma_f32_32x32x16_bf16 v[24:39], v[80:83], v[228:231], v[24:39]
  v_max3_u32 v170, v170, v80, v81
  v_max3_u32 v170, v170, v82, v83
  s_waitcnt vmcnt(4)
  v_mfma_f32_32x32x16_bf16 v[24:39], v[84:87], v[232:235], v[24:39]
  v_max3_u32 v170, v170, v84, v85
  v_max3_u32 v170, v170, v86, v87
  s_waitcnt vmcnt(3)
  v_mfma_f32_32x32x16_bf16 v[24:39], v[88:91], v[236:239], v[24:39]
  v_max3_u32 v170, v170, v88, v89
  v_max3_u32 v170, v170, v90, v91
  s_waitcnt vmcnt(2)
  v_mfma_f32_32x32x16_bf16 v[24:39], v[92:95], v[240:243], v[24:39]
  v_max3_u32 v170, v170, v92, v93
  v_max3_u32 v170, v170, v94, v95
  s_waitcnt vmcnt(1)
  v_mfma_f32_32x32x16_bf16 v[24:39], v[96:99], v[244:247], v[24:39]
  v_max3_u32 v170, v170, v96, v97
  v_max3_u32 v170, v170, v98, v99
  s_waitcnt vmcnt(0)
  v_mfma_f32_32x32x16_bf16 v[24:39], v[100:103], v[248:251], v[24:39]
  v_max3_u32 v170, v170, v100, v101
  v_max3_u32 v170, v170, v102, v103
  v_cmp_eq_u32 vcc, -1, v170
  s_cbranch_vccz L_osent_ok_h
  s_nop 15
  s_sub_u32 s26, s26, 1
  s_cbranch_scc0 L_osent_h
L_osent_ok_h:
  s_nop 15
  s_lshl_b32 s36, s31, 12
  s_add_u32 s36, s36, 106496
  v_add_u32 v168, s36, v1
  v_and_b32 v169, 31, v0
  s_lshl_b32 s36, s43, 5
  v_add_u32 v169, s36, v169
  v_lshrrev_b32 v173, 5, v0
  v_lshlrev_b32 v173, 15, v173
  v_lshl_add_u32 v173, v169, 2, v173
  s_lshl_b32 s36, s42, 16
  v_pk_add_f32 v[24:25], v[24:25], v[8:9] neg_lo:[0,1] neg_hi:[0,1]
  v_pk_add_f32 v[26:27], v[26:27], v[10:11] neg_lo:[0,1] neg_hi:[0,1]
  v_pk_add_f32 v[28:29], v[28:29], v[12:13] neg_lo:[0,1] neg_hi:[0,1]
  v_pk_add_f32 v[30:31], v[30:31], v[14:15] neg_lo:[0,1] neg_hi:[0,1]
  v_pk_add_f32 v[32:33], v[32:33], v[16:17] neg_lo:[0,1] neg_hi:[0,1]
  v_pk_add_f32 v[34:35], v[34:35], v[18:19] neg_lo:[0,1] neg_hi:[0,1]
  v_pk_add_f32 v[36:37], v[36:37], v[20:21] neg_lo:[0,1] neg_hi:[0,1]
  v_pk_add_f32 v[38:39], v[38:39], v[22:23] neg_lo:[0,1] neg_hi:[0,1]
  s_barrier
  ds_read_b128 v[40:43], v168 offset:0
  ds_read_b128 v[44:47], v168 offset:1024
  ds_read_b128 v[48:51], v168 offset:2048
  ds_read_b128 v[52:55], v168 offset:3072
  s_waitcnt lgkmcnt(3)
  v_pk_add_f32 v[24:25], v[24:25], v[40:41]
  v_pk_fma_f32 v[8:9], v[184:185], v[24:25], v[8:9]
  v_pk_add_f32 v[26:27], v[26:27], v[42:43]
  v_pk_fma_f32 v[10:11], v[186:187], v[26:27], v[10:11]
  s_add_u32 s37, s36, 0
  buffer_store_dword v8, v173, s[68:71], s37 offen
  s_add_u32 s37, s36, 2048
  buffer_store_dword v9, v173, s[68:71], s37 offen
  s_add_u32 s37, s36, 4096
  buffer_store_dword v10, v173, s[68:71], s37 offen
  s_add_u32 s37, s36, 6144
  buffer_store_dword v11, v173, s[68:71], s37 offen
  s_waitcnt lgkmcnt(2)
  v_pk_add_f32 v[28:29], v[28:29], v[44:45]
  v_pk_fma_f32 v[12:13], v[188:189], v[28:29], v[12:13]
  v_pk_add_f32 v[30:31], v[30:31], v[46:47]
  v_pk_fma_f32 v[14:15], v[190:191], v[30:31], v[14:15]
  s_add_u32 s37, s36, 8192
  buffer_store_dword v12, v173, s[68:71], s37 offen
  s_add_u32 s37, s36, 10240
  buffer_store_dword v13, v173, s[68:71], s37 offen
  s_add_u32 s37, s36, 12288
  buffer_store_dword v14, v173, s[68:71], s37 offen
  s_add_u32 s37, s36, 14336
  buffer_store_dword v15, v173, s[68:71], s37 offen
  s_waitcnt lgkmcnt(1)
  v_pk_add_f32 v[32:33], v[32:33], v[48:49]
  v_pk_fma_f32 v[16:17], v[192:193], v[32:33], v[16:17]
  v_pk_add_f32 v[34:35], v[34:35], v[50:51]
  v_pk_fma_f32 v[18:19], v[194:195], v[34:35], v[18:19]
  s_add_u32 s37, s36, 16384
  buffer_store_dword v16, v173, s[68:71], s37 offen
  s_add_u32 s37, s36, 18432
  buffer_store_dword v17, v173, s[68:71], s37 offen
  s_add_u32 s37, s36, 20480
  buffer_store_dword v18, v173, s[68:71], s37 offen
  s_add_u32 s37, s36, 22528
  buffer_store_dword v19, v173, s[68:71], s37 offen
  s_waitcnt lgkmcnt(0)
  v_pk_add_f32 v[36:37], v[36:37], v[52:53]
  v_pk_fma_f32 v[20:21], v[196:197], v[36:37], v[20:21]
  v_pk_add_f32 v[38:39], v[38:39], v[54:55]
  v_pk_fma_f32 v[22:23], v[198:199], v[38:39], v[22:23]
  s_add_u32 s37, s36, 24576
  buffer_store_dword v20, v173, s[68:71], s37 offen
  s_add_u32 s37, s36, 26624
  buffer_store_dword v21, v173, s[68:71], s37 offen
  s_add_u32 s37, s36, 28672
  buffer_store_dword v22, v173, s[68:71], s37 offen
  s_add_u32 s37, s36, 30720
  buffer_store_dword v23, v173, s[68:71], s37 offen
L_f_end:
L_f_exit:

  s_endpgm
.section .rodata,"a"
.p2align 6
.amdhsa_kernel gated_mix__mha_block__ssm_conv_s5__prompt_kernel
  .amdhsa_next_free_vgpr 252
  .amdhsa_next_free_sgpr 102
  .amdhsa_accum_offset 252
  .amdhsa_group_segment_fixed_size 0
  .amdhsa_kernarg_size 128
  .amdhsa_user_sgpr_count 2
  .amdhsa_user_sgpr_kernarg_segment_ptr 1
  .amdhsa_system_sgpr_workgroup_id_x 1
  .amdhsa_float_denorm_mode_32 3
.end_amdhsa_kernel
```
